```python
import torch

def _softmax(x, axis=-1):
    return torch.softmax(x, dim=axis)
def _gelu(x):
    return torch.nn.functional.gelu(x, approximate="tanh")
def _silu(x):
    return torch.nn.functional.silu(x)
def _sigmoid(x):
    return torch.sigmoid(x)
def _layernorm(x, axis=-1, eps=1e-5):
    m = x.mean(dim=axis, keepdim=True)
    v = x.var(dim=axis, keepdim=True, unbiased=False)
    return (x - m) / torch.sqrt(v + eps)
def _scatter_add(tgt, idx, src, axis=0):
    return tgt.clone().index_add_(axis, idx, src)
def _segment_sum(src, seg, n):
    out = torch.zeros((n,) + src.shape[1:], dtype=src.dtype)
    return out.index_add_(0, seg, src)
def _pad(x, pw):
    flat = tuple(v for pair in reversed(pw) for v in pair)
    return torch.nn.functional.pad(x, flat)

kernel_name = 'concat_heads__linear_kernel_hedgehog__mha_block__prompt'

def setup_inputs():

    _w = (lambda a: (lambda t: t.to(torch.bfloat16) if t.is_floating_point() else t)(torch.as_tensor(a)))
    def _A_setup():
        B, S, D, H = 1, 2048, 640, 32
        Dh = D // H
        return {
            "x": _w((lambda *s: torch.randn(*s, dtype=torch.bfloat16) * 0.4)(B, S, D)),
            "wqkv": _w((lambda *s: torch.randn(*s, dtype=torch.bfloat16) * 0.4)(D, 3 * D)),
            "w_phi": _w((lambda *s: torch.randn(*s, dtype=torch.bfloat16) * 0.4)(H, Dh, Dh) * (Dh ** -0.5)),
            "wo": _w((lambda *s: torch.randn(*s, dtype=torch.bfloat16) * 0.05)(D, D)),
        }
    _A_in = _A_setup()

    def _B_setup():
        B, S, D, H = 1, 2048, 640, 32
        return {
            "x": _w((lambda *s: torch.randn(*s, dtype=torch.bfloat16) * 0.2)(B, S, D)),
            "wqkv": _w((lambda *s: torch.randn(*s, dtype=torch.bfloat16) * 0.2)(D, 3 * D)),
            "wo": _w((lambda *s: torch.randn(*s, dtype=torch.bfloat16) * 0.05)(D, D)),
        }
    _B_in = _B_setup()

    return {
        "A_x": _A_in["x"],
        "A_wqkv": _A_in["wqkv"],
        "A_w_phi": _A_in["w_phi"],
        "A_wo": _A_in["wo"],
        "B_x": _B_in["x"],
        "B_wqkv": _B_in["wqkv"],
        "B_wo": _B_in["wo"],
    }

def reference(A_x, A_wqkv, A_w_phi, A_wo, B_x, B_wqkv, B_wo):
    def _A_ref(x, wqkv, w_phi, wo):
        B, S, D = x.shape
        H = 32; Dh = D // H
        qkv = (lambda x, *d: x.permute(*d))((x @ wqkv).reshape(B, S, 3, H, Dh), 2, 0, 3, 1, 4)
        q, k, v = qkv[0], qkv[1], qkv[2]
        pq = torch.einsum("bhsd,hdf->bhsf", q, w_phi)
        pk = torch.einsum("bhsd,hdf->bhsf", k, w_phi)
        phi_q = torch.concatenate([_softmax(pq, axis=-1), _softmax(-pq, axis=-1)], axis=-1)
        phi_k = torch.concatenate([_softmax(pk, axis=-1), _softmax(-pk, axis=-1)], axis=-1)
        kv = torch.einsum("bhsf,bhsd->bhfd", phi_k, v)
        z  = torch.einsum("bhsf->bhf", phi_k)
        num = torch.einsum("bhqf,bhfd->bhqd", phi_q, kv)
        den = torch.einsum("bhqf,bhf->bhq", phi_q, z)[..., None] + 1e-6
        o = num / den
        return (lambda x, *d: x.permute(*d))(o, 0, 2, 1, 3).reshape(B, S, D) @ wo

    def _B_ref(x, wqkv, wo):
        B, S, D = x.shape
        H = 32
        Dh = D // H
        qkv = (lambda x, *d: x.permute(*d))((x @ wqkv).reshape(B, S, 3, H, Dh), 2, 0, 3, 1, 4)
        q, k, v = qkv[0], qkv[1], qkv[2]
        scores = torch.einsum("bhqd,bhkd->bhqk", q, k) * (Dh ** -0.5)
        p = _softmax(scores, axis=-1)
        o = torch.einsum("bhqk,bhkd->bhqd", p, v)
        return (lambda x, *d: x.permute(*d))(o, 0, 2, 1, 3).reshape(B, S, D) @ wo

    a = _A_ref(A_x, A_wqkv, A_w_phi, A_wo)
    b = _B_ref(B_x, B_wqkv, B_wo)
    return torch.concatenate([a, b], axis=-1)
```

```asm
; @launch grid=(256,1,1) block=(512,1,1) lds=163840
.amdgcn_target "amdgcn-amd-amdhsa--gfx950"
.text
.globl concat_heads__linear_kernel_hedgehog__mha_block__prompt_kernel
.p2align 8
.type concat_heads__linear_kernel_hedgehog__mha_block__prompt_kernel,@function
concat_heads__linear_kernel_hedgehog__mha_block__prompt_kernel:
    s_cmp_ge_u32 s2, 256
    s_cbranch_scc1 concat_heads__linear_kernel_hedgehog__mha_block__prompt_kernel_done
    s_load_dwordx4 s[20:23], s[0:1], 0
    s_load_dwordx4 s[24:27], s[0:1], 32
    s_load_dwordx4 s[4:7], s[0:1], 64
    s_load_dwordx2 s[28:29], s[0:1], 16
    v_and_b32 v1, 63, v0
    v_lshrrev_b32 v2, 6, v0
    v_and_b32 v3, 31, v1
    v_readfirstlane_b32 s32, v2
    v_lshrrev_b32 v131, 5, v1
    v_lshlrev_b32 v2, 4, v1
    v_lshlrev_b32 v132, 3, v3
    s_and_b32 s39, s2, 7
    s_lshr_b32 s64, s2, 3
    s_lshl_b32 s33, s39, 2
    s_lshr_b32 s45, s64, 3
    s_add_u32 s33, s33, s45
    s_and_b32 s34, s64, 7
    s_and_b32 s35, s32, 3
    s_lshr_b32 s36, s32, 2
    s_lshr_b32 s65, s39, 1
    s_lshl_b32 s37, s65, 2
    s_and_b32 s30, s39, 1
    s_cmp_eq_u32 s30, 0
    s_cbranch_scc0 concat_heads__linear_kernel_hedgehog__mha_block__prompt_kernel_map1
    s_lshr_b32 s46, s64, 3
    s_add_u32 s37, s37, s46
    s_and_b32 s38, s64, 7
    s_mov_b32 s31, 0
    s_branch concat_heads__linear_kernel_hedgehog__mha_block__prompt_kernel_map2
concat_heads__linear_kernel_hedgehog__mha_block__prompt_kernel_map1:
    s_mul_i32 s46, s64, 37
    s_lshr_b32 s46, s46, 8
    s_add_u32 s37, s37, s46
    s_mul_i32 s46, s46, 7
    s_sub_u32 s38, s64, s46
    s_add_u32 s38, s38, 8
    s_cmp_ge_u32 s64, 28
    s_cselect_b32 s31, 1, 0
concat_heads__linear_kernel_hedgehog__mha_block__prompt_kernel_map2:
    s_mov_b32 s40, 1.0
    s_mov_b32 s41, -1.0
    s_mov_b32 s42, 0x000fffff
    s_mov_b32 s43, 0x000fffff
    s_and_b32 s45, s33, 1
    s_mul_i32 s66, s33, 5
    s_add_u32 s66, s66, s45
    s_lshr_b32 s66, s66, 1
    s_add_u32 s67, s66, 2
    s_cmp_eq_u32 s45, 1
    s_cselect_b32 s46, 3, 0
    s_sub_u32 s67, s67, s46
    s_lshl_b32 s68, s45, 3
    s_mul_i32 s53, s33, 81920
    s_add_u32 s53, s53, 22020096
    s_waitcnt lgkmcnt(0)
    s_mov_b32 s8, s6
    s_and_b32 s9, s7, 0xffff
    s_mov_b32 s10, 0x2000000
    s_mov_b32 s11, 0x20000
    v_mov_b32 v188, 0
    v_mov_b32 v189, 0
    v_mov_b32 v190, 0
    v_mov_b32 v191, 0
    s_cmp_eq_u32 s32, 7
    s_cbranch_scc0 cpf_1
    s_and_b32 s54, s64, 15
    s_cmp_eq_u32 s54, 0
    s_cbranch_scc0 cpf_1
    s_getpc_b64 s[54:55]
cpf_1_pc:
    s_sub_u32 s54, s54, cpf_1_pc-concat_heads__linear_kernel_hedgehog__mha_block__prompt_kernel
    s_subb_u32 s55, s55, 0
    s_mov_b32 s56, concat_heads__linear_kernel_hedgehog__mha_block__prompt_kernel_end-concat_heads__linear_kernel_hedgehog__mha_block__prompt_kernel
    v_lshlrev_b32 v228, 7, v1
    v_cmp_gt_u32 vcc, s56, v228
    s_and_b64 exec, vcc, vcc
    s_cbranch_execz cpf_1_x
    global_load_dword v229, v228, s[54:55]
    v_add_u32 v228, 8192, v228
    v_cmp_gt_u32 vcc, s56, v228
    s_and_b64 exec, vcc, vcc
    s_cbranch_execz cpf_1_x
    global_load_dword v229, v228, s[54:55]
    v_add_u32 v228, 8192, v228
    v_cmp_gt_u32 vcc, s56, v228
    s_and_b64 exec, vcc, vcc
    s_cbranch_execz cpf_1_x
    global_load_dword v229, v228, s[54:55]
    v_add_u32 v228, 8192, v228
    v_cmp_gt_u32 vcc, s56, v228
    s_and_b64 exec, vcc, vcc
    s_cbranch_execz cpf_1_x
    global_load_dword v229, v228, s[54:55]
    v_add_u32 v228, 8192, v228
    v_cmp_gt_u32 vcc, s56, v228
    s_and_b64 exec, vcc, vcc
    s_cbranch_execz cpf_1_x
    global_load_dword v229, v228, s[54:55]
    v_add_u32 v228, 8192, v228
    v_cmp_gt_u32 vcc, s56, v228
    s_and_b64 exec, vcc, vcc
    s_cbranch_execz cpf_1_x
    global_load_dword v229, v228, s[54:55]
    v_add_u32 v228, 8192, v228
cpf_1_x:
    s_mov_b64 exec, -1
cpf_1:
    s_cmp_eq_u32 s31, 1
    s_cbranch_scc1 concat_heads__linear_kernel_hedgehog__mha_block__prompt_kernel_prep
    s_cmp_eq_u32 s36, 1
    s_cbranch_scc1 concat_heads__linear_kernel_hedgehog__mha_block__prompt_kernel_loader
    s_cmp_ge_u32 s38, 10
    s_cbranch_scc1 concat_heads__linear_kernel_hedgehog__mha_block__prompt_kernel_compN
    s_lshr_b32 s44, s35, 1
    s_lshl_b32 s44, s44, 6
    v_add_u32 v18, s44, v3
    v_lshlrev_b32 v18, 6, v18
    v_add_u32 v18, 32768, v18
    v_lshrrev_b32 v19, 2, v3
    v_and_b32 v19, 3, v19
    v_xor_b32 v19, v19, v131
    v_lshlrev_b32 v20, 4, v19
    v_add_u32 v4, v18, v20
    v_xor_b32 v19, 2, v19
    v_lshlrev_b32 v20, 4, v19
    v_add_u32 v5, v18, v20
    v_add_u32 v6, 65536, v4
    v_add_u32 v7, 65536, v5
    v_lshrrev_b32 v16, 2, v1
    v_and_b32 v16, 3, v16
    v_lshlrev_b32 v18, 11, v131
    v_lshlrev_b32 v19, 8, v16
    v_add_u32 v18, v18, v19
    v_lshrrev_b32 v19, 4, v1
    v_and_b32 v19, 1, v19
    v_lshlrev_b32 v19, 5, v19
    v_add_u32 v18, v18, v19
    v_and_b32 v19, 3, v1
    v_lshlrev_b32 v19, 3, v19
    v_add_u32 v18, v18, v19
    v_add_u32 v18, 40960, v18
    s_and_b32 s44, s35, 1
    s_lshl_b32 s44, s44, 1
    s_add_u32 s45, s44, 0
    v_xor_b32 v19, s45, v16
    v_lshlrev_b32 v19, 6, v19
    v_add_u32 v8, v18, v19
    v_add_u32 v10, 65536, v8
    s_add_u32 s45, s44, 1
    v_xor_b32 v19, s45, v16
    v_lshlrev_b32 v19, 6, v19
    v_add_u32 v9, v18, v19
    v_add_u32 v11, 65536, v9
    s_lshl_b32 s44, s38, 4
    s_and_b32 s45, s35, 1
    s_lshl_b32 s45, s45, 3
    s_add_u32 s44, s44, s45
    v_add_u32 v144, s44, v131
    v_lshlrev_b32 v144, 15, v144
    s_lshl_b32 s44, s37, 7
    s_lshr_b32 s45, s35, 1
    s_lshl_b32 s45, s45, 6
    s_add_u32 s44, s44, s45
    v_add_u32 v145, s44, v3
    v_lshlrev_b32 v145, 4, v145
    v_add_u32 v128, v144, v145
    s_mov_b32 s61, 16777216
    s_mov_b32 s62, 1.0
    s_cmp_lt_u32 s38, 5
    s_cselect_b32 s62, 0x3ea52b5c, s62
    v_mov_b32 v64, 0
    v_mov_b32 v65, 0
    v_mov_b32 v66, 0
    v_mov_b32 v67, 0
    v_mov_b32 v68, 0
    v_mov_b32 v69, 0
    v_mov_b32 v70, 0
    v_mov_b32 v71, 0
    v_mov_b32 v72, 0
    v_mov_b32 v73, 0
    v_mov_b32 v74, 0
    v_mov_b32 v75, 0
    v_mov_b32 v76, 0
    v_mov_b32 v77, 0
    v_mov_b32 v78, 0
    v_mov_b32 v79, 0
    v_mov_b32 v80, 0
    v_mov_b32 v81, 0
    v_mov_b32 v82, 0
    v_mov_b32 v83, 0
    v_mov_b32 v84, 0
    v_mov_b32 v85, 0
    v_mov_b32 v86, 0
    v_mov_b32 v87, 0
    v_mov_b32 v88, 0
    v_mov_b32 v89, 0
    v_mov_b32 v90, 0
    v_mov_b32 v91, 0
    v_mov_b32 v92, 0
    v_mov_b32 v93, 0
    v_mov_b32 v94, 0
    v_mov_b32 v95, 0
    v_mov_b32 v96, 0
    v_mov_b32 v97, 0
    v_mov_b32 v98, 0
    v_mov_b32 v99, 0
    v_mov_b32 v100, 0
    v_mov_b32 v101, 0
    v_mov_b32 v102, 0
    v_mov_b32 v103, 0
    v_mov_b32 v104, 0
    v_mov_b32 v105, 0
    v_mov_b32 v106, 0
    v_mov_b32 v107, 0
    v_mov_b32 v108, 0
    v_mov_b32 v109, 0
    v_mov_b32 v110, 0
    v_mov_b32 v111, 0
    v_mov_b32 v112, 0
    v_mov_b32 v113, 0
    v_mov_b32 v114, 0
    v_mov_b32 v115, 0
    v_mov_b32 v116, 0
    v_mov_b32 v117, 0
    v_mov_b32 v118, 0
    v_mov_b32 v119, 0
    v_mov_b32 v120, 0
    v_mov_b32 v121, 0
    v_mov_b32 v122, 0
    v_mov_b32 v123, 0
    v_mov_b32 v124, 0
    v_mov_b32 v125, 0
    v_mov_b32 v126, 0
    v_mov_b32 v127, 0
    s_mov_b32 s63, 0
    s_barrier
    ds_read_b128 v[16:19], v4 offset:0
    ds_read_b64_tr_b16 v[24:25], v8 offset:0
    ds_read_b64_tr_b16 v[26:27], v8 offset:1024
    ds_read_b128 v[20:23], v4 offset:2048
    ds_read_b64_tr_b16 v[28:29], v9 offset:0
    ds_read_b64_tr_b16 v[30:31], v9 offset:1024
    s_mov_b32 s46, 0
concat_heads__linear_kernel_hedgehog__mha_block__prompt_kernel_kT_loop:
    s_waitcnt lgkmcnt(0)
    v_mfma_f32_32x32x16_bf16 v[64:79], v[24:27], v[16:19], v[64:79]
    ds_read_b128 v[32:35], v5 offset:0
    ds_read_b64_tr_b16 v[40:41], v8 offset:4096
    ds_read_b64_tr_b16 v[42:43], v8 offset:5120
    v_mfma_f32_32x32x16_bf16 v[80:95], v[24:27], v[20:23], v[80:95]
    ds_read_b128 v[36:39], v5 offset:2048
    ds_read_b64_tr_b16 v[44:45], v9 offset:4096
    ds_read_b64_tr_b16 v[46:47], v9 offset:5120
    v_mfma_f32_32x32x16_bf16 v[96:111], v[28:31], v[16:19], v[96:111]
    v_mfma_f32_32x32x16_bf16 v[112:127], v[28:31], v[20:23], v[112:127]
    s_waitcnt lgkmcnt(0)
    s_barrier
    v_mfma_f32_32x32x16_bf16 v[64:79], v[40:43], v[32:35], v[64:79]
    ds_read_b128 v[16:19], v4 offset:16384
    ds_read_b64_tr_b16 v[24:25], v8 offset:16384
    ds_read_b64_tr_b16 v[26:27], v8 offset:17408
    v_mfma_f32_32x32x16_bf16 v[80:95], v[40:43], v[36:39], v[80:95]
    ds_read_b128 v[20:23], v4 offset:18432
    ds_read_b64_tr_b16 v[28:29], v9 offset:16384
    ds_read_b64_tr_b16 v[30:31], v9 offset:17408
    v_mfma_f32_32x32x16_bf16 v[96:111], v[44:47], v[32:35], v[96:111]
    v_mfma_f32_32x32x16_bf16 v[112:127], v[44:47], v[36:39], v[112:127]
    s_cmp_eq_u32 s46, 1
    s_cbranch_scc1 concat_heads__linear_kernel_hedgehog__mha_block__prompt_kernel_kT_fp
concat_heads__linear_kernel_hedgehog__mha_block__prompt_kernel_kT_fpr:
    s_waitcnt lgkmcnt(0)
    v_mfma_f32_32x32x16_bf16 v[64:79], v[24:27], v[16:19], v[64:79]
    ds_read_b128 v[32:35], v5 offset:16384
    ds_read_b64_tr_b16 v[40:41], v8 offset:20480
    ds_read_b64_tr_b16 v[42:43], v8 offset:21504
    v_mfma_f32_32x32x16_bf16 v[80:95], v[24:27], v[20:23], v[80:95]
    ds_read_b128 v[36:39], v5 offset:18432
    ds_read_b64_tr_b16 v[44:45], v9 offset:20480
    ds_read_b64_tr_b16 v[46:47], v9 offset:21504
    v_mfma_f32_32x32x16_bf16 v[96:111], v[28:31], v[16:19], v[96:111]
    v_mfma_f32_32x32x16_bf16 v[112:127], v[28:31], v[20:23], v[112:127]
    s_waitcnt lgkmcnt(0)
    s_barrier
    v_mfma_f32_32x32x16_bf16 v[64:79], v[40:43], v[32:35], v[64:79]
    ds_read_b128 v[16:19], v4 offset:32768
    ds_read_b64_tr_b16 v[24:25], v8 offset:32768
    ds_read_b64_tr_b16 v[26:27], v8 offset:33792
    v_mfma_f32_32x32x16_bf16 v[80:95], v[40:43], v[36:39], v[80:95]
    ds_read_b128 v[20:23], v4 offset:34816
    ds_read_b64_tr_b16 v[28:29], v9 offset:32768
    ds_read_b64_tr_b16 v[30:31], v9 offset:33792
    v_mfma_f32_32x32x16_bf16 v[96:111], v[44:47], v[32:35], v[96:111]
    v_mfma_f32_32x32x16_bf16 v[112:127], v[44:47], v[36:39], v[112:127]
    s_waitcnt lgkmcnt(0)
    v_mfma_f32_32x32x16_bf16 v[64:79], v[24:27], v[16:19], v[64:79]
    ds_read_b128 v[32:35], v5 offset:32768
    ds_read_b64_tr_b16 v[40:41], v8 offset:36864
    ds_read_b64_tr_b16 v[42:43], v8 offset:37888
    v_mfma_f32_32x32x16_bf16 v[80:95], v[24:27], v[20:23], v[80:95]
    ds_read_b128 v[36:39], v5 offset:34816
    ds_read_b64_tr_b16 v[44:45], v9 offset:36864
    ds_read_b64_tr_b16 v[46:47], v9 offset:37888
    v_mfma_f32_32x32x16_bf16 v[96:111], v[28:31], v[16:19], v[96:111]
    v_mfma_f32_32x32x16_bf16 v[112:127], v[28:31], v[20:23], v[112:127]
    s_waitcnt lgkmcnt(0)
    s_barrier
    v_mfma_f32_32x32x16_bf16 v[64:79], v[40:43], v[32:35], v[64:79]
    ds_read_b128 v[16:19], v4 offset:49152
    ds_read_b64_tr_b16 v[24:25], v8 offset:49152
    ds_read_b64_tr_b16 v[26:27], v8 offset:50176
    v_mfma_f32_32x32x16_bf16 v[80:95], v[40:43], v[36:39], v[80:95]
    ds_read_b128 v[20:23], v4 offset:51200
    ds_read_b64_tr_b16 v[28:29], v9 offset:49152
    ds_read_b64_tr_b16 v[30:31], v9 offset:50176
    v_mfma_f32_32x32x16_bf16 v[96:111], v[44:47], v[32:35], v[96:111]
    v_mfma_f32_32x32x16_bf16 v[112:127], v[44:47], v[36:39], v[112:127]
    s_waitcnt lgkmcnt(0)
    v_mfma_f32_32x32x16_bf16 v[64:79], v[24:27], v[16:19], v[64:79]
    ds_read_b128 v[32:35], v5 offset:49152
    ds_read_b64_tr_b16 v[40:41], v8 offset:53248
    ds_read_b64_tr_b16 v[42:43], v8 offset:54272
    v_mfma_f32_32x32x16_bf16 v[80:95], v[24:27], v[20:23], v[80:95]
    ds_read_b128 v[36:39], v5 offset:51200
    ds_read_b64_tr_b16 v[44:45], v9 offset:53248
    ds_read_b64_tr_b16 v[46:47], v9 offset:54272
    v_mfma_f32_32x32x16_bf16 v[96:111], v[28:31], v[16:19], v[96:111]
    v_mfma_f32_32x32x16_bf16 v[112:127], v[28:31], v[20:23], v[112:127]
    s_waitcnt lgkmcnt(0)
    s_barrier
    v_mfma_f32_32x32x16_bf16 v[64:79], v[40:43], v[32:35], v[64:79]
    ds_read_b128 v[16:19], v6 offset:0
    ds_read_b64_tr_b16 v[24:25], v10 offset:0
    ds_read_b64_tr_b16 v[26:27], v10 offset:1024
    v_mfma_f32_32x32x16_bf16 v[80:95], v[40:43], v[36:39], v[80:95]
    ds_read_b128 v[20:23], v6 offset:2048
    ds_read_b64_tr_b16 v[28:29], v11 offset:0
    ds_read_b64_tr_b16 v[30:31], v11 offset:1024
    v_mfma_f32_32x32x16_bf16 v[96:111], v[44:47], v[32:35], v[96:111]
    v_mfma_f32_32x32x16_bf16 v[112:127], v[44:47], v[36:39], v[112:127]
    s_cmp_eq_u32 s46, 2
    s_cbranch_scc1 concat_heads__linear_kernel_hedgehog__mha_block__prompt_kernel_kT_epi
concat_heads__linear_kernel_hedgehog__mha_block__prompt_kernel_kT_epir:
    s_waitcnt lgkmcnt(0)
    v_mfma_f32_32x32x16_bf16 v[64:79], v[24:27], v[16:19], v[64:79]
    ds_read_b128 v[32:35], v7 offset:0
    ds_read_b64_tr_b16 v[40:41], v10 offset:4096
    ds_read_b64_tr_b16 v[42:43], v10 offset:5120
    v_mfma_f32_32x32x16_bf16 v[80:95], v[24:27], v[20:23], v[80:95]
    ds_read_b128 v[36:39], v7 offset:2048
    ds_read_b64_tr_b16 v[44:45], v11 offset:4096
    ds_read_b64_tr_b16 v[46:47], v11 offset:5120
    v_mfma_f32_32x32x16_bf16 v[96:111], v[28:31], v[16:19], v[96:111]
    v_mfma_f32_32x32x16_bf16 v[112:127], v[28:31], v[20:23], v[112:127]
    s_waitcnt lgkmcnt(0)
    s_barrier
    v_mfma_f32_32x32x16_bf16 v[64:79], v[40:43], v[32:35], v[64:79]
    ds_read_b128 v[16:19], v6 offset:16384
    ds_read_b64_tr_b16 v[24:25], v10 offset:16384
    ds_read_b64_tr_b16 v[26:27], v10 offset:17408
    v_mfma_f32_32x32x16_bf16 v[80:95], v[40:43], v[36:39], v[80:95]
    ds_read_b128 v[20:23], v6 offset:18432
    ds_read_b64_tr_b16 v[28:29], v11 offset:16384
    ds_read_b64_tr_b16 v[30:31], v11 offset:17408
    v_mfma_f32_32x32x16_bf16 v[96:111], v[44:47], v[32:35], v[96:111]
    v_mfma_f32_32x32x16_bf16 v[112:127], v[44:47], v[36:39], v[112:127]
    s_waitcnt lgkmcnt(0)
    v_mfma_f32_32x32x16_bf16 v[64:79], v[24:27], v[16:19], v[64:79]
    ds_read_b128 v[32:35], v7 offset:16384
    ds_read_b64_tr_b16 v[40:41], v10 offset:20480
    ds_read_b64_tr_b16 v[42:43], v10 offset:21504
    v_mfma_f32_32x32x16_bf16 v[80:95], v[24:27], v[20:23], v[80:95]
    ds_read_b128 v[36:39], v7 offset:18432
    ds_read_b64_tr_b16 v[44:45], v11 offset:20480
    ds_read_b64_tr_b16 v[46:47], v11 offset:21504
    v_mfma_f32_32x32x16_bf16 v[96:111], v[28:31], v[16:19], v[96:111]
    v_mfma_f32_32x32x16_bf16 v[112:127], v[28:31], v[20:23], v[112:127]
    s_waitcnt lgkmcnt(0)
    s_barrier
    v_mfma_f32_32x32x16_bf16 v[64:79], v[40:43], v[32:35], v[64:79]
    ds_read_b128 v[16:19], v6 offset:32768
    ds_read_b64_tr_b16 v[24:25], v10 offset:32768
    ds_read_b64_tr_b16 v[26:27], v10 offset:33792
    v_mfma_f32_32x32x16_bf16 v[80:95], v[40:43], v[36:39], v[80:95]
    ds_read_b128 v[20:23], v6 offset:34816
    ds_read_b64_tr_b16 v[28:29], v11 offset:32768
    ds_read_b64_tr_b16 v[30:31], v11 offset:33792
    v_mfma_f32_32x32x16_bf16 v[96:111], v[44:47], v[32:35], v[96:111]
    v_mfma_f32_32x32x16_bf16 v[112:127], v[44:47], v[36:39], v[112:127]
    s_waitcnt lgkmcnt(0)
    v_mfma_f32_32x32x16_bf16 v[64:79], v[24:27], v[16:19], v[64:79]
    ds_read_b128 v[32:35], v7 offset:32768
    ds_read_b64_tr_b16 v[40:41], v10 offset:36864
    ds_read_b64_tr_b16 v[42:43], v10 offset:37888
    v_mfma_f32_32x32x16_bf16 v[80:95], v[24:27], v[20:23], v[80:95]
    ds_read_b128 v[36:39], v7 offset:34816
    ds_read_b64_tr_b16 v[44:45], v11 offset:36864
    ds_read_b64_tr_b16 v[46:47], v11 offset:37888
    v_mfma_f32_32x32x16_bf16 v[96:111], v[28:31], v[16:19], v[96:111]
    v_mfma_f32_32x32x16_bf16 v[112:127], v[28:31], v[20:23], v[112:127]
    s_cmp_eq_u32 s46, 2
    s_cbranch_scc1 concat_heads__linear_kernel_hedgehog__mha_block__prompt_kernel_kT_vm
concat_heads__linear_kernel_hedgehog__mha_block__prompt_kernel_kT_vmr:
    s_waitcnt lgkmcnt(0)
    s_barrier
    v_mfma_f32_32x32x16_bf16 v[64:79], v[40:43], v[32:35], v[64:79]
    ds_read_b128 v[16:19], v6 offset:49152
    ds_read_b64_tr_b16 v[24:25], v10 offset:49152
    ds_read_b64_tr_b16 v[26:27], v10 offset:50176
    v_mfma_f32_32x32x16_bf16 v[80:95], v[40:43], v[36:39], v[80:95]
    ds_read_b128 v[20:23], v6 offset:51200
    ds_read_b64_tr_b16 v[28:29], v11 offset:49152
    ds_read_b64_tr_b16 v[30:31], v11 offset:50176
    v_mfma_f32_32x32x16_bf16 v[96:111], v[44:47], v[32:35], v[96:111]
    v_mfma_f32_32x32x16_bf16 v[112:127], v[44:47], v[36:39], v[112:127]
    s_cmp_eq_u32 s46, 2
    s_cbranch_scc1 concat_heads__linear_kernel_hedgehog__mha_block__prompt_kernel_kT_sig
concat_heads__linear_kernel_hedgehog__mha_block__prompt_kernel_kT_sigr:
    s_waitcnt lgkmcnt(0)
    v_mfma_f32_32x32x16_bf16 v[64:79], v[24:27], v[16:19], v[64:79]
    ds_read_b128 v[32:35], v7 offset:49152
    ds_read_b64_tr_b16 v[40:41], v10 offset:53248
    ds_read_b64_tr_b16 v[42:43], v10 offset:54272
    v_mfma_f32_32x32x16_bf16 v[80:95], v[24:27], v[20:23], v[80:95]
    ds_read_b128 v[36:39], v7 offset:51200
    ds_read_b64_tr_b16 v[44:45], v11 offset:53248
    ds_read_b64_tr_b16 v[46:47], v11 offset:54272
    v_mfma_f32_32x32x16_bf16 v[96:111], v[28:31], v[16:19], v[96:111]
    v_mfma_f32_32x32x16_bf16 v[112:127], v[28:31], v[20:23], v[112:127]
    s_waitcnt lgkmcnt(0)
    s_barrier
    v_mfma_f32_32x32x16_bf16 v[64:79], v[40:43], v[32:35], v[64:79]
    ds_read_b128 v[16:19], v4 offset:0
    ds_read_b64_tr_b16 v[24:25], v8 offset:0
    ds_read_b64_tr_b16 v[26:27], v8 offset:1024
    v_mfma_f32_32x32x16_bf16 v[80:95], v[40:43], v[36:39], v[80:95]
    ds_read_b128 v[20:23], v4 offset:2048
    ds_read_b64_tr_b16 v[28:29], v9 offset:0
    ds_read_b64_tr_b16 v[30:31], v9 offset:1024
    v_mfma_f32_32x32x16_bf16 v[96:111], v[44:47], v[32:35], v[96:111]
    v_mfma_f32_32x32x16_bf16 v[112:127], v[44:47], v[36:39], v[112:127]
    s_add_u32 s46, s46, 1
    s_cmp_lt_u32 s46, 5
    s_cbranch_scc1 concat_heads__linear_kernel_hedgehog__mha_block__prompt_kernel_kT_loop
concat_heads__linear_kernel_hedgehog__mha_block__prompt_kernel_kT_epi:
    s_waitcnt lgkmcnt(0)
    v_mul_f32 v64, s62, v64
    v_mul_f32 v65, s62, v65
    v_mul_f32 v66, s62, v66
    v_mul_f32 v67, s62, v67
    v_mul_f32 v68, s62, v68
    v_mul_f32 v69, s62, v69
    v_mul_f32 v70, s62, v70
    v_mul_f32 v71, s62, v71
    v_cvt_pk_bf16_f32 v144, v64, v65
    v_cvt_pk_bf16_f32 v145, v66, v67
    v_cvt_pk_bf16_f32 v146, v68, v69
    v_cvt_pk_bf16_f32 v147, v70, v71
    s_add_u32 s55, s61, 0
    v_permlane32_swap_b32 v144, v146
    v_permlane32_swap_b32 v145, v147
    buffer_store_dwordx4 v[144:147], v128, s[8:11], s55 offen sc1
    v_mul_f32 v72, s62, v72
    v_mul_f32 v73, s62, v73
    v_mul_f32 v74, s62, v74
    v_mul_f32 v75, s62, v75
    v_mul_f32 v76, s62, v76
    v_mul_f32 v77, s62, v77
    v_mul_f32 v78, s62, v78
    v_mul_f32 v79, s62, v79
    v_cvt_pk_bf16_f32 v148, v72, v73
    v_cvt_pk_bf16_f32 v149, v74, v75
    v_cvt_pk_bf16_f32 v150, v76, v77
    v_cvt_pk_bf16_f32 v151, v78, v79
    s_add_u32 s55, s61, 65536
    v_permlane32_swap_b32 v148, v150
    v_permlane32_swap_b32 v149, v151
    buffer_store_dwordx4 v[148:151], v128, s[8:11], s55 offen sc1
    v_mul_f32 v80, s62, v80
    v_mul_f32 v81, s62, v81
    v_mul_f32 v82, s62, v82
    v_mul_f32 v83, s62, v83
    v_mul_f32 v84, s62, v84
    v_mul_f32 v85, s62, v85
    v_mul_f32 v86, s62, v86
    v_mul_f32 v87, s62, v87
    v_cvt_pk_bf16_f32 v152, v80, v81
    v_cvt_pk_bf16_f32 v153, v82, v83
    v_cvt_pk_bf16_f32 v154, v84, v85
    v_cvt_pk_bf16_f32 v155, v86, v87
    s_add_u32 s55, s61, 512
    v_permlane32_swap_b32 v152, v154
    v_permlane32_swap_b32 v153, v155
    buffer_store_dwordx4 v[152:155], v128, s[8:11], s55 offen sc1
    v_mul_f32 v88, s62, v88
    v_mul_f32 v89, s62, v89
    v_mul_f32 v90, s62, v90
    v_mul_f32 v91, s62, v91
    v_mul_f32 v92, s62, v92
    v_mul_f32 v93, s62, v93
    v_mul_f32 v94, s62, v94
    v_mul_f32 v95, s62, v95
    v_cvt_pk_bf16_f32 v156, v88, v89
    v_cvt_pk_bf16_f32 v157, v90, v91
    v_cvt_pk_bf16_f32 v158, v92, v93
    v_cvt_pk_bf16_f32 v159, v94, v95
    s_add_u32 s55, s61, 66048
    v_permlane32_swap_b32 v156, v158
    v_permlane32_swap_b32 v157, v159
    buffer_store_dwordx4 v[156:159], v128, s[8:11], s55 offen sc1
    v_mul_f32 v96, s62, v96
    v_mul_f32 v97, s62, v97
    v_mul_f32 v98, s62, v98
    v_mul_f32 v99, s62, v99
    v_mul_f32 v100, s62, v100
    v_mul_f32 v101, s62, v101
    v_mul_f32 v102, s62, v102
    v_mul_f32 v103, s62, v103
    v_cvt_pk_bf16_f32 v144, v96, v97
    v_cvt_pk_bf16_f32 v145, v98, v99
    v_cvt_pk_bf16_f32 v146, v100, v101
    v_cvt_pk_bf16_f32 v147, v102, v103
    s_add_u32 s55, s61, 131072
    v_permlane32_swap_b32 v144, v146
    v_permlane32_swap_b32 v145, v147
    buffer_store_dwordx4 v[144:147], v128, s[8:11], s55 offen sc1
    v_mul_f32 v104, s62, v104
    v_mul_f32 v105, s62, v105
    v_mul_f32 v106, s62, v106
    v_mul_f32 v107, s62, v107
    v_mul_f32 v108, s62, v108
    v_mul_f32 v109, s62, v109
    v_mul_f32 v110, s62, v110
    v_mul_f32 v111, s62, v111
    v_cvt_pk_bf16_f32 v148, v104, v105
    v_cvt_pk_bf16_f32 v149, v106, v107
    v_cvt_pk_bf16_f32 v150, v108, v109
    v_cvt_pk_bf16_f32 v151, v110, v111
    s_add_u32 s55, s61, 196608
    v_permlane32_swap_b32 v148, v150
    v_permlane32_swap_b32 v149, v151
    buffer_store_dwordx4 v[148:151], v128, s[8:11], s55 offen sc1
    v_mul_f32 v112, s62, v112
    v_mul_f32 v113, s62, v113
    v_mul_f32 v114, s62, v114
    v_mul_f32 v115, s62, v115
    v_mul_f32 v116, s62, v116
    v_mul_f32 v117, s62, v117
    v_mul_f32 v118, s62, v118
    v_mul_f32 v119, s62, v119
    v_cvt_pk_bf16_f32 v152, v112, v113
    v_cvt_pk_bf16_f32 v153, v114, v115
    v_cvt_pk_bf16_f32 v154, v116, v117
    v_cvt_pk_bf16_f32 v155, v118, v119
    s_add_u32 s55, s61, 131584
    v_permlane32_swap_b32 v152, v154
    v_permlane32_swap_b32 v153, v155
    buffer_store_dwordx4 v[152:155], v128, s[8:11], s55 offen sc1
    v_mul_f32 v120, s62, v120
    v_mul_f32 v121, s62, v121
    v_mul_f32 v122, s62, v122
    v_mul_f32 v123, s62, v123
    v_mul_f32 v124, s62, v124
    v_mul_f32 v125, s62, v125
    v_mul_f32 v126, s62, v126
    v_mul_f32 v127, s62, v127
    v_cvt_pk_bf16_f32 v156, v120, v121
    v_cvt_pk_bf16_f32 v157, v122, v123
    v_cvt_pk_bf16_f32 v158, v124, v125
    v_cvt_pk_bf16_f32 v159, v126, v127
    s_add_u32 s55, s61, 197120
    v_permlane32_swap_b32 v156, v158
    v_permlane32_swap_b32 v157, v159
    buffer_store_dwordx4 v[156:159], v128, s[8:11], s55 offen sc1
    s_cmp_eq_u32 s63, 1
    s_cbranch_scc1 concat_heads__linear_kernel_hedgehog__mha_block__prompt_kernel_kT_fin
    s_mov_b32 s63, 1
    s_sub_u32 s61, s61, 0x1000000
    s_mov_b32 s62, 1.0
    v_mov_b32 v64, 0
    v_mov_b32 v65, 0
    v_mov_b32 v66, 0
    v_mov_b32 v67, 0
    v_mov_b32 v68, 0
    v_mov_b32 v69, 0
    v_mov_b32 v70, 0
    v_mov_b32 v71, 0
    v_mov_b32 v72, 0
    v_mov_b32 v73, 0
    v_mov_b32 v74, 0
    v_mov_b32 v75, 0
    v_mov_b32 v76, 0
    v_mov_b32 v77, 0
    v_mov_b32 v78, 0
    v_mov_b32 v79, 0
    v_mov_b32 v80, 0
    v_mov_b32 v81, 0
    v_mov_b32 v82, 0
    v_mov_b32 v83, 0
    v_mov_b32 v84, 0
    v_mov_b32 v85, 0
    v_mov_b32 v86, 0
    v_mov_b32 v87, 0
    v_mov_b32 v88, 0
    v_mov_b32 v89, 0
    v_mov_b32 v90, 0
    v_mov_b32 v91, 0
    v_mov_b32 v92, 0
    v_mov_b32 v93, 0
    v_mov_b32 v94, 0
    v_mov_b32 v95, 0
    v_mov_b32 v96, 0
    v_mov_b32 v97, 0
    v_mov_b32 v98, 0
    v_mov_b32 v99, 0
    v_mov_b32 v100, 0
    v_mov_b32 v101, 0
    v_mov_b32 v102, 0
    v_mov_b32 v103, 0
    v_mov_b32 v104, 0
    v_mov_b32 v105, 0
    v_mov_b32 v106, 0
    v_mov_b32 v107, 0
    v_mov_b32 v108, 0
    v_mov_b32 v109, 0
    v_mov_b32 v110, 0
    v_mov_b32 v111, 0
    v_mov_b32 v112, 0
    v_mov_b32 v113, 0
    v_mov_b32 v114, 0
    v_mov_b32 v115, 0
    v_mov_b32 v116, 0
    v_mov_b32 v117, 0
    v_mov_b32 v118, 0
    v_mov_b32 v119, 0
    v_mov_b32 v120, 0
    v_mov_b32 v121, 0
    v_mov_b32 v122, 0
    v_mov_b32 v123, 0
    v_mov_b32 v124, 0
    v_mov_b32 v125, 0
    v_mov_b32 v126, 0
    v_mov_b32 v127, 0
    s_branch concat_heads__linear_kernel_hedgehog__mha_block__prompt_kernel_kT_epir
concat_heads__linear_kernel_hedgehog__mha_block__prompt_kernel_kT_fin:
    s_mul_i32 s55, s32, 3
    s_add_u32 s55, s55, 0
    s_min_u32 s55, s55, 21
    s_cmp_ge_u32 s55, 11
    s_cselect_b32 s56, 1, 0
    s_mul_i32 s57, s56, 11
    s_sub_u32 s55, s55, s57
    s_mul_i32 s57, s56, 11264
    s_lshl_b32 s58, s55, 10
    s_add_u32 s50, s57, s58
    s_lshl_b32 s56, s56, 3
    s_cmp_ge_u32 s55, 6
    s_cbranch_scc1 kd_2_v
    s_lshr_b32 s57, s55, 1
    s_add_u32 s58, s66, s57
    s_cmp_eq_u32 s57, 2
    s_cselect_b32 s58, s67, s58
    s_add_u32 s58, s58, 80
    s_lshl_b32 s58, s58, 15
    s_lshl_b32 s56, s56, 11
    s_add_u32 s58, s58, s56
    s_and_b32 s57, s55, 1
    s_lshl_b32 s57, s57, 10
    s_add_u32 s58, s58, s57
    s_add_u32 s44, s58, 16777216
    s_mov_b32 s47, 2048
    s_branch kd_2_e
kd_2_v:
    s_mul_i32 s56, s56, 5120
    s_sub_u32 s57, s55, 6
    s_lshl_b32 s57, s57, 10
    s_add_u32 s56, s56, s57
    s_add_u32 s44, s56, s53
    s_mov_b32 s47, 5120
kd_2_e:
    s_add_u32 s44, s44, s47
    s_mul_i32 s55, s32, 3
    s_add_u32 s55, s55, 1
    s_min_u32 s55, s55, 21
    s_cmp_ge_u32 s55, 11
    s_cselect_b32 s56, 1, 0
    s_mul_i32 s57, s56, 11
    s_sub_u32 s55, s55, s57
    s_mul_i32 s57, s56, 11264
    s_lshl_b32 s58, s55, 10
    s_add_u32 s51, s57, s58
    s_lshl_b32 s56, s56, 3
    s_cmp_ge_u32 s55, 6
    s_cbranch_scc1 kd_3_v
    s_lshr_b32 s57, s55, 1
    s_add_u32 s58, s66, s57
    s_cmp_eq_u32 s57, 2
    s_cselect_b32 s58, s67, s58
    s_add_u32 s58, s58, 80
    s_lshl_b32 s58, s58, 15
    s_lshl_b32 s56, s56, 11
    s_add_u32 s58, s58, s56
    s_and_b32 s57, s55, 1
    s_lshl_b32 s57, s57, 10
    s_add_u32 s58, s58, s57
    s_add_u32 s45, s58, 16777216
    s_mov_b32 s48, 2048
    s_branch kd_3_e
kd_3_v:
    s_mul_i32 s56, s56, 5120
    s_sub_u32 s57, s55, 6
    s_lshl_b32 s57, s57, 10
    s_add_u32 s56, s56, s57
    s_add_u32 s45, s56, s53
    s_mov_b32 s48, 5120
kd_3_e:
    s_add_u32 s45, s45, s48
    s_mul_i32 s55, s32, 3
    s_add_u32 s55, s55, 2
    s_min_u32 s55, s55, 21
    s_cmp_ge_u32 s55, 11
    s_cselect_b32 s56, 1, 0
    s_mul_i32 s57, s56, 11
    s_sub_u32 s55, s55, s57
    s_mul_i32 s57, s56, 11264
    s_lshl_b32 s58, s55, 10
    s_add_u32 s52, s57, s58
    s_lshl_b32 s56, s56, 3
    s_cmp_ge_u32 s55, 6
    s_cbranch_scc1 kd_4_v
    s_lshr_b32 s57, s55, 1
    s_add_u32 s58, s66, s57
    s_cmp_eq_u32 s57, 2
    s_cselect_b32 s58, s67, s58
    s_add_u32 s58, s58, 80
    s_lshl_b32 s58, s58, 15
    s_lshl_b32 s56, s56, 11
    s_add_u32 s58, s58, s56
    s_and_b32 s57, s55, 1
    s_lshl_b32 s57, s57, 10
    s_add_u32 s58, s58, s57
    s_add_u32 s46, s58, 16777216
    s_mov_b32 s49, 2048
    s_branch kd_4_e
kd_4_v:
    s_mul_i32 s56, s56, 5120
    s_sub_u32 s57, s55, 6
    s_lshl_b32 s57, s57, 10
    s_add_u32 s56, s56, s57
    s_add_u32 s46, s56, s53
    s_mov_b32 s49, 5120
kd_4_e:
    s_add_u32 s46, s46, s49
    s_branch concat_heads__linear_kernel_hedgehog__mha_block__prompt_kernel_cdone
concat_heads__linear_kernel_hedgehog__mha_block__prompt_kernel_kT_vm:
    s_waitcnt vmcnt(0)
    s_branch concat_heads__linear_kernel_hedgehog__mha_block__prompt_kernel_kT_vmr
concat_heads__linear_kernel_hedgehog__mha_block__prompt_kernel_kT_fp:
    s_cmp_eq_u32 s32, 0
    s_cbranch_scc0 concat_heads__linear_kernel_hedgehog__mha_block__prompt_kernel_kT_fpr
    v_mov_b32 v160, 124
    global_load_dword v161, v160, s[4:5] sc1
    s_branch concat_heads__linear_kernel_hedgehog__mha_block__prompt_kernel_kT_fpr
concat_heads__linear_kernel_hedgehog__mha_block__prompt_kernel_kT_sig:
    s_cmp_eq_u32 s32, 0
    s_cbranch_scc0 concat_heads__linear_kernel_hedgehog__mha_block__prompt_kernel_kT_sigr
    v_readfirstlane_b32 s58, v161
    s_cmp_ge_u32 s58, 16
    s_cbranch_scc1 cp_5
    v_mov_b32 v160, 124
    global_load_dword v161, v160, s[4:5] sc1
    s_mov_b32 s59, 0
cp_6:
    s_waitcnt vmcnt(0)
    v_readfirstlane_b32 s58, v161
    s_cmp_ge_u32 s58, 16
    s_cbranch_scc1 cp_6_ok
    s_sleep 16
    global_load_dword v161, v160, s[4:5] sc1
    s_add_u32 s59, s59, 1
    s_cmp_lt_u32 s59, 50000
    s_cbranch_scc1 cp_6
cp_6_ok:
cp_5:
    s_lshl_b32 s54, s38, 7
    s_lshl_b32 s55, s37, 2
    s_add_u32 s54, s54, s55
    s_add_u32 s54, s54, 13778944
    v_mov_b32 v160, 0
    v_mov_b32 v161, 1
    s_mov_b64 exec, 1
    buffer_store_dword v161, v160, s[8:11], s54 offen sc1
    s_mov_b64 exec, -1
    s_branch concat_heads__linear_kernel_hedgehog__mha_block__prompt_kernel_kT_sigr
concat_heads__linear_kernel_hedgehog__mha_block__prompt_kernel_compN:
    s_lshr_b32 s44, s35, 1
    s_lshl_b32 s44, s44, 6
    v_add_u32 v18, s44, v3
    v_lshlrev_b32 v18, 6, v18
    v_add_u32 v18, 32768, v18
    v_lshrrev_b32 v19, 2, v3
    v_and_b32 v19, 3, v19
    v_xor_b32 v19, v19, v131
    v_lshlrev_b32 v20, 4, v19
    v_add_u32 v4, v18, v20
    v_xor_b32 v19, 2, v19
    v_lshlrev_b32 v20, 4, v19
    v_add_u32 v5, v18, v20
    v_add_u32 v6, 65536, v4
    v_add_u32 v7, 65536, v5
    v_lshrrev_b32 v16, 2, v1
    v_and_b32 v16, 3, v16
    v_lshlrev_b32 v18, 11, v131
    v_lshlrev_b32 v19, 8, v16
    v_add_u32 v18, v18, v19
    v_lshrrev_b32 v19, 4, v1
    v_and_b32 v19, 1, v19
    v_lshlrev_b32 v19, 5, v19
    v_add_u32 v18, v18, v19
    v_and_b32 v19, 3, v1
    v_lshlrev_b32 v19, 3, v19
    v_add_u32 v18, v18, v19
    v_add_u32 v18, 40960, v18
    s_and_b32 s44, s35, 1
    s_lshl_b32 s44, s44, 1
    s_add_u32 s45, s44, 0
    v_xor_b32 v19, s45, v16
    v_lshlrev_b32 v19, 6, v19
    v_add_u32 v8, v18, v19
    v_add_u32 v10, 65536, v8
    s_add_u32 s45, s44, 1
    v_xor_b32 v19, s45, v16
    v_lshlrev_b32 v19, 6, v19
    v_add_u32 v9, v18, v19
    v_add_u32 v11, 65536, v9
    s_sub_u32 s44, s38, 10
    s_lshl_b32 s44, s44, 7
    s_and_b32 s45, s35, 1
    s_lshl_b32 s45, s45, 6
    s_add_u32 s44, s44, s45
    s_mul_i32 s61, s37, 5120
    s_add_u32 s61, s61, 22020096
    s_lshr_b32 s45, s35, 1
    s_mul_i32 s45, s45, 2560
    s_add_u32 s61, s61, s45
    v_mul_u32_u24 v144, 320, v131
    s_mov_b32 s45, 81920
    v_add_u32 v145, s44, v3
    v_add_u32 v145, 0, v145
    v_mul_u32_u24 v146, 3277, v145
    v_lshrrev_b32 v146, 16, v146
    v_mul_u32_u24 v147, 20, v146
    v_sub_u32 v147, v145, v147
    v_lshlrev_b32 v147, 4, v147
    v_mul_lo_u32 v146, v146, s45
    v_add3_u32 v128, v146, v147, v144
    v_add_u32 v145, s44, v3
    v_add_u32 v145, 32, v145
    v_mul_u32_u24 v146, 3277, v145
    v_lshrrev_b32 v146, 16, v146
    v_mul_u32_u24 v147, 20, v146
    v_sub_u32 v147, v145, v147
    v_lshlrev_b32 v147, 4, v147
    v_mul_lo_u32 v146, v146, s45
    v_add3_u32 v129, v146, v147, v144
    v_mov_b32 v64, 0
    v_mov_b32 v65, 0
    v_mov_b32 v66, 0
    v_mov_b32 v67, 0
    v_mov_b32 v68, 0
    v_mov_b32 v69, 0
    v_mov_b32 v70, 0
    v_mov_b32 v71, 0
    v_mov_b32 v72, 0
    v_mov_b32 v73, 0
    v_mov_b32 v74, 0
    v_mov_b32 v75, 0
    v_mov_b32 v76, 0
    v_mov_b32 v77, 0
    v_mov_b32 v78, 0
    v_mov_b32 v79, 0
    v_mov_b32 v80, 0
    v_mov_b32 v81, 0
    v_mov_b32 v82, 0
    v_mov_b32 v83, 0
    v_mov_b32 v84, 0
    v_mov_b32 v85, 0
    v_mov_b32 v86, 0
    v_mov_b32 v87, 0
    v_mov_b32 v88, 0
    v_mov_b32 v89, 0
    v_mov_b32 v90, 0
    v_mov_b32 v91, 0
    v_mov_b32 v92, 0
    v_mov_b32 v93, 0
    v_mov_b32 v94, 0
    v_mov_b32 v95, 0
    v_mov_b32 v96, 0
    v_mov_b32 v97, 0
    v_mov_b32 v98, 0
    v_mov_b32 v99, 0
    v_mov_b32 v100, 0
    v_mov_b32 v101, 0
    v_mov_b32 v102, 0
    v_mov_b32 v103, 0
    v_mov_b32 v104, 0
    v_mov_b32 v105, 0
    v_mov_b32 v106, 0
    v_mov_b32 v107, 0
    v_mov_b32 v108, 0
    v_mov_b32 v109, 0
    v_mov_b32 v110, 0
    v_mov_b32 v111, 0
    v_mov_b32 v112, 0
    v_mov_b32 v113, 0
    v_mov_b32 v114, 0
    v_mov_b32 v115, 0
    v_mov_b32 v116, 0
    v_mov_b32 v117, 0
    v_mov_b32 v118, 0
    v_mov_b32 v119, 0
    v_mov_b32 v120, 0
    v_mov_b32 v121, 0
    v_mov_b32 v122, 0
    v_mov_b32 v123, 0
    v_mov_b32 v124, 0
    v_mov_b32 v125, 0
    v_mov_b32 v126, 0
    v_mov_b32 v127, 0
    s_mov_b32 s63, 0
    s_barrier
    ds_read_b128 v[16:19], v4 offset:0
    ds_read_b64_tr_b16 v[24:25], v8 offset:0
    ds_read_b64_tr_b16 v[26:27], v8 offset:1024
    ds_read_b128 v[20:23], v4 offset:2048
    ds_read_b64_tr_b16 v[28:29], v9 offset:0
    ds_read_b64_tr_b16 v[30:31], v9 offset:1024
    s_mov_b32 s46, 0
concat_heads__linear_kernel_hedgehog__mha_block__prompt_kernel_kN_loop:
    s_waitcnt lgkmcnt(0)
    v_mfma_f32_32x32x16_bf16 v[64:79], v[16:19], v[24:27], v[64:79]
    ds_read_b128 v[32:35], v5 offset:0
    ds_read_b64_tr_b16 v[40:41], v8 offset:4096
    ds_read_b64_tr_b16 v[42:43], v8 offset:5120
    v_mfma_f32_32x32x16_bf16 v[96:111], v[20:23], v[24:27], v[96:111]
    ds_read_b128 v[36:39], v5 offset:2048
    ds_read_b64_tr_b16 v[44:45], v9 offset:4096
    ds_read_b64_tr_b16 v[46:47], v9 offset:5120
    v_mfma_f32_32x32x16_bf16 v[80:95], v[16:19], v[28:31], v[80:95]
    v_mfma_f32_32x32x16_bf16 v[112:127], v[20:23], v[28:31], v[112:127]
    s_waitcnt lgkmcnt(0)
    s_barrier
    v_mfma_f32_32x32x16_bf16 v[64:79], v[32:35], v[40:43], v[64:79]
    ds_read_b128 v[16:19], v4 offset:16384
    ds_read_b64_tr_b16 v[24:25], v8 offset:16384
    ds_read_b64_tr_b16 v[26:27], v8 offset:17408
    v_mfma_f32_32x32x16_bf16 v[96:111], v[36:39], v[40:43], v[96:111]
    ds_read_b128 v[20:23], v4 offset:18432
    ds_read_b64_tr_b16 v[28:29], v9 offset:16384
    ds_read_b64_tr_b16 v[30:31], v9 offset:17408
    v_mfma_f32_32x32x16_bf16 v[80:95], v[32:35], v[44:47], v[80:95]
    v_mfma_f32_32x32x16_bf16 v[112:127], v[36:39], v[44:47], v[112:127]
    s_cmp_eq_u32 s46, 1
    s_cbranch_scc1 concat_heads__linear_kernel_hedgehog__mha_block__prompt_kernel_kN_fp
concat_heads__linear_kernel_hedgehog__mha_block__prompt_kernel_kN_fpr:
    s_waitcnt lgkmcnt(0)
    v_mfma_f32_32x32x16_bf16 v[64:79], v[16:19], v[24:27], v[64:79]
    ds_read_b128 v[32:35], v5 offset:16384
    ds_read_b64_tr_b16 v[40:41], v8 offset:20480
    ds_read_b64_tr_b16 v[42:43], v8 offset:21504
    v_mfma_f32_32x32x16_bf16 v[96:111], v[20:23], v[24:27], v[96:111]
    ds_read_b128 v[36:39], v5 offset:18432
    ds_read_b64_tr_b16 v[44:45], v9 offset:20480
    ds_read_b64_tr_b16 v[46:47], v9 offset:21504
    v_mfma_f32_32x32x16_bf16 v[80:95], v[16:19], v[28:31], v[80:95]
    v_mfma_f32_32x32x16_bf16 v[112:127], v[20:23], v[28:31], v[112:127]
    s_waitcnt lgkmcnt(0)
    s_barrier
    v_mfma_f32_32x32x16_bf16 v[64:79], v[32:35], v[40:43], v[64:79]
    ds_read_b128 v[16:19], v4 offset:32768
    ds_read_b64_tr_b16 v[24:25], v8 offset:32768
    ds_read_b64_tr_b16 v[26:27], v8 offset:33792
    v_mfma_f32_32x32x16_bf16 v[96:111], v[36:39], v[40:43], v[96:111]
    ds_read_b128 v[20:23], v4 offset:34816
    ds_read_b64_tr_b16 v[28:29], v9 offset:32768
    ds_read_b64_tr_b16 v[30:31], v9 offset:33792
    v_mfma_f32_32x32x16_bf16 v[80:95], v[32:35], v[44:47], v[80:95]
    v_mfma_f32_32x32x16_bf16 v[112:127], v[36:39], v[44:47], v[112:127]
    s_waitcnt lgkmcnt(0)
    v_mfma_f32_32x32x16_bf16 v[64:79], v[16:19], v[24:27], v[64:79]
    ds_read_b128 v[32:35], v5 offset:32768
    ds_read_b64_tr_b16 v[40:41], v8 offset:36864
    ds_read_b64_tr_b16 v[42:43], v8 offset:37888
    v_mfma_f32_32x32x16_bf16 v[96:111], v[20:23], v[24:27], v[96:111]
    ds_read_b128 v[36:39], v5 offset:34816
    ds_read_b64_tr_b16 v[44:45], v9 offset:36864
    ds_read_b64_tr_b16 v[46:47], v9 offset:37888
    v_mfma_f32_32x32x16_bf16 v[80:95], v[16:19], v[28:31], v[80:95]
    v_mfma_f32_32x32x16_bf16 v[112:127], v[20:23], v[28:31], v[112:127]
    s_waitcnt lgkmcnt(0)
    s_barrier
    v_mfma_f32_32x32x16_bf16 v[64:79], v[32:35], v[40:43], v[64:79]
    ds_read_b128 v[16:19], v4 offset:49152
    ds_read_b64_tr_b16 v[24:25], v8 offset:49152
    ds_read_b64_tr_b16 v[26:27], v8 offset:50176
    v_mfma_f32_32x32x16_bf16 v[96:111], v[36:39], v[40:43], v[96:111]
    ds_read_b128 v[20:23], v4 offset:51200
    ds_read_b64_tr_b16 v[28:29], v9 offset:49152
    ds_read_b64_tr_b16 v[30:31], v9 offset:50176
    v_mfma_f32_32x32x16_bf16 v[80:95], v[32:35], v[44:47], v[80:95]
    v_mfma_f32_32x32x16_bf16 v[112:127], v[36:39], v[44:47], v[112:127]
    s_waitcnt lgkmcnt(0)
    v_mfma_f32_32x32x16_bf16 v[64:79], v[16:19], v[24:27], v[64:79]
    ds_read_b128 v[32:35], v5 offset:49152
    ds_read_b64_tr_b16 v[40:41], v8 offset:53248
    ds_read_b64_tr_b16 v[42:43], v8 offset:54272
    v_mfma_f32_32x32x16_bf16 v[96:111], v[20:23], v[24:27], v[96:111]
    ds_read_b128 v[36:39], v5 offset:51200
    ds_read_b64_tr_b16 v[44:45], v9 offset:53248
    ds_read_b64_tr_b16 v[46:47], v9 offset:54272
    v_mfma_f32_32x32x16_bf16 v[80:95], v[16:19], v[28:31], v[80:95]
    v_mfma_f32_32x32x16_bf16 v[112:127], v[20:23], v[28:31], v[112:127]
    s_waitcnt lgkmcnt(0)
    s_barrier
    v_mfma_f32_32x32x16_bf16 v[64:79], v[32:35], v[40:43], v[64:79]
    ds_read_b128 v[16:19], v6 offset:0
    ds_read_b64_tr_b16 v[24:25], v10 offset:0
    ds_read_b64_tr_b16 v[26:27], v10 offset:1024
    v_mfma_f32_32x32x16_bf16 v[96:111], v[36:39], v[40:43], v[96:111]
    ds_read_b128 v[20:23], v6 offset:2048
    ds_read_b64_tr_b16 v[28:29], v11 offset:0
    ds_read_b64_tr_b16 v[30:31], v11 offset:1024
    v_mfma_f32_32x32x16_bf16 v[80:95], v[32:35], v[44:47], v[80:95]
    v_mfma_f32_32x32x16_bf16 v[112:127], v[36:39], v[44:47], v[112:127]
    s_cmp_eq_u32 s46, 2
    s_cbranch_scc1 concat_heads__linear_kernel_hedgehog__mha_block__prompt_kernel_kN_epi
concat_heads__linear_kernel_hedgehog__mha_block__prompt_kernel_kN_epir:
    s_waitcnt lgkmcnt(0)
    v_mfma_f32_32x32x16_bf16 v[64:79], v[16:19], v[24:27], v[64:79]
    ds_read_b128 v[32:35], v7 offset:0
    ds_read_b64_tr_b16 v[40:41], v10 offset:4096
    ds_read_b64_tr_b16 v[42:43], v10 offset:5120
    v_mfma_f32_32x32x16_bf16 v[96:111], v[20:23], v[24:27], v[96:111]
    ds_read_b128 v[36:39], v7 offset:2048
    ds_read_b64_tr_b16 v[44:45], v11 offset:4096
    ds_read_b64_tr_b16 v[46:47], v11 offset:5120
    v_mfma_f32_32x32x16_bf16 v[80:95], v[16:19], v[28:31], v[80:95]
    v_mfma_f32_32x32x16_bf16 v[112:127], v[20:23], v[28:31], v[112:127]
    s_waitcnt lgkmcnt(0)
    s_barrier
    v_mfma_f32_32x32x16_bf16 v[64:79], v[32:35], v[40:43], v[64:79]
    ds_read_b128 v[16:19], v6 offset:16384
    ds_read_b64_tr_b16 v[24:25], v10 offset:16384
    ds_read_b64_tr_b16 v[26:27], v10 offset:17408
    v_mfma_f32_32x32x16_bf16 v[96:111], v[36:39], v[40:43], v[96:111]
    ds_read_b128 v[20:23], v6 offset:18432
    ds_read_b64_tr_b16 v[28:29], v11 offset:16384
    ds_read_b64_tr_b16 v[30:31], v11 offset:17408
    v_mfma_f32_32x32x16_bf16 v[80:95], v[32:35], v[44:47], v[80:95]
    v_mfma_f32_32x32x16_bf16 v[112:127], v[36:39], v[44:47], v[112:127]
    s_waitcnt lgkmcnt(0)
    v_mfma_f32_32x32x16_bf16 v[64:79], v[16:19], v[24:27], v[64:79]
    ds_read_b128 v[32:35], v7 offset:16384
    ds_read_b64_tr_b16 v[40:41], v10 offset:20480
    ds_read_b64_tr_b16 v[42:43], v10 offset:21504
    v_mfma_f32_32x32x16_bf16 v[96:111], v[20:23], v[24:27], v[96:111]
    ds_read_b128 v[36:39], v7 offset:18432
    ds_read_b64_tr_b16 v[44:45], v11 offset:20480
    ds_read_b64_tr_b16 v[46:47], v11 offset:21504
    v_mfma_f32_32x32x16_bf16 v[80:95], v[16:19], v[28:31], v[80:95]
    v_mfma_f32_32x32x16_bf16 v[112:127], v[20:23], v[28:31], v[112:127]
    s_waitcnt lgkmcnt(0)
    s_barrier
    v_mfma_f32_32x32x16_bf16 v[64:79], v[32:35], v[40:43], v[64:79]
    ds_read_b128 v[16:19], v6 offset:32768
    ds_read_b64_tr_b16 v[24:25], v10 offset:32768
    ds_read_b64_tr_b16 v[26:27], v10 offset:33792
    v_mfma_f32_32x32x16_bf16 v[96:111], v[36:39], v[40:43], v[96:111]
    ds_read_b128 v[20:23], v6 offset:34816
    ds_read_b64_tr_b16 v[28:29], v11 offset:32768
    ds_read_b64_tr_b16 v[30:31], v11 offset:33792
    v_mfma_f32_32x32x16_bf16 v[80:95], v[32:35], v[44:47], v[80:95]
    v_mfma_f32_32x32x16_bf16 v[112:127], v[36:39], v[44:47], v[112:127]
    s_waitcnt lgkmcnt(0)
    v_mfma_f32_32x32x16_bf16 v[64:79], v[16:19], v[24:27], v[64:79]
    ds_read_b128 v[32:35], v7 offset:32768
    ds_read_b64_tr_b16 v[40:41], v10 offset:36864
    ds_read_b64_tr_b16 v[42:43], v10 offset:37888
    v_mfma_f32_32x32x16_bf16 v[96:111], v[20:23], v[24:27], v[96:111]
    ds_read_b128 v[36:39], v7 offset:34816
    ds_read_b64_tr_b16 v[44:45], v11 offset:36864
    ds_read_b64_tr_b16 v[46:47], v11 offset:37888
    v_mfma_f32_32x32x16_bf16 v[80:95], v[16:19], v[28:31], v[80:95]
    v_mfma_f32_32x32x16_bf16 v[112:127], v[20:23], v[28:31], v[112:127]
    s_cmp_eq_u32 s46, 2
    s_cbranch_scc1 concat_heads__linear_kernel_hedgehog__mha_block__prompt_kernel_kN_vm
concat_heads__linear_kernel_hedgehog__mha_block__prompt_kernel_kN_vmr:
    s_waitcnt lgkmcnt(0)
    s_barrier
    v_mfma_f32_32x32x16_bf16 v[64:79], v[32:35], v[40:43], v[64:79]
    ds_read_b128 v[16:19], v6 offset:49152
    ds_read_b64_tr_b16 v[24:25], v10 offset:49152
    ds_read_b64_tr_b16 v[26:27], v10 offset:50176
    v_mfma_f32_32x32x16_bf16 v[96:111], v[36:39], v[40:43], v[96:111]
    ds_read_b128 v[20:23], v6 offset:51200
    ds_read_b64_tr_b16 v[28:29], v11 offset:49152
    ds_read_b64_tr_b16 v[30:31], v11 offset:50176
    v_mfma_f32_32x32x16_bf16 v[80:95], v[32:35], v[44:47], v[80:95]
    v_mfma_f32_32x32x16_bf16 v[112:127], v[36:39], v[44:47], v[112:127]
    s_cmp_eq_u32 s46, 2
    s_cbranch_scc1 concat_heads__linear_kernel_hedgehog__mha_block__prompt_kernel_kN_sig
concat_heads__linear_kernel_hedgehog__mha_block__prompt_kernel_kN_sigr:
    s_waitcnt lgkmcnt(0)
    v_mfma_f32_32x32x16_bf16 v[64:79], v[16:19], v[24:27], v[64:79]
    ds_read_b128 v[32:35], v7 offset:49152
    ds_read_b64_tr_b16 v[40:41], v10 offset:53248
    ds_read_b64_tr_b16 v[42:43], v10 offset:54272
    v_mfma_f32_32x32x16_bf16 v[96:111], v[20:23], v[24:27], v[96:111]
    ds_read_b128 v[36:39], v7 offset:51200
    ds_read_b64_tr_b16 v[44:45], v11 offset:53248
    ds_read_b64_tr_b16 v[46:47], v11 offset:54272
    v_mfma_f32_32x32x16_bf16 v[80:95], v[16:19], v[28:31], v[80:95]
    v_mfma_f32_32x32x16_bf16 v[112:127], v[20:23], v[28:31], v[112:127]
    s_waitcnt lgkmcnt(0)
    s_barrier
    v_mfma_f32_32x32x16_bf16 v[64:79], v[32:35], v[40:43], v[64:79]
    ds_read_b128 v[16:19], v4 offset:0
    ds_read_b64_tr_b16 v[24:25], v8 offset:0
    ds_read_b64_tr_b16 v[26:27], v8 offset:1024
    v_mfma_f32_32x32x16_bf16 v[96:111], v[36:39], v[40:43], v[96:111]
    ds_read_b128 v[20:23], v4 offset:2048
    ds_read_b64_tr_b16 v[28:29], v9 offset:0
    ds_read_b64_tr_b16 v[30:31], v9 offset:1024
    v_mfma_f32_32x32x16_bf16 v[80:95], v[32:35], v[44:47], v[80:95]
    v_mfma_f32_32x32x16_bf16 v[112:127], v[36:39], v[44:47], v[112:127]
    s_add_u32 s46, s46, 1
    s_cmp_lt_u32 s46, 5
    s_cbranch_scc1 concat_heads__linear_kernel_hedgehog__mha_block__prompt_kernel_kN_loop
concat_heads__linear_kernel_hedgehog__mha_block__prompt_kernel_kN_epi:
    s_waitcnt lgkmcnt(0)
    v_cvt_pk_bf16_f32 v144, v64, v65
    v_cvt_pk_bf16_f32 v145, v66, v67
    v_cvt_pk_bf16_f32 v146, v68, v69
    v_cvt_pk_bf16_f32 v147, v70, v71
    buffer_store_dwordx4 v[144:147], v128, s[8:11], s61 offen offset:0 sc1
    v_cvt_pk_bf16_f32 v148, v72, v73
    v_cvt_pk_bf16_f32 v149, v74, v75
    v_cvt_pk_bf16_f32 v150, v76, v77
    v_cvt_pk_bf16_f32 v151, v78, v79
    buffer_store_dwordx4 v[148:151], v128, s[8:11], s61 offen offset:640 sc1
    v_cvt_pk_bf16_f32 v152, v96, v97
    v_cvt_pk_bf16_f32 v153, v98, v99
    v_cvt_pk_bf16_f32 v154, v100, v101
    v_cvt_pk_bf16_f32 v155, v102, v103
    buffer_store_dwordx4 v[152:155], v128, s[8:11], s61 offen offset:1280 sc1
    v_cvt_pk_bf16_f32 v156, v104, v105
    v_cvt_pk_bf16_f32 v157, v106, v107
    v_cvt_pk_bf16_f32 v158, v108, v109
    v_cvt_pk_bf16_f32 v159, v110, v111
    buffer_store_dwordx4 v[156:159], v128, s[8:11], s61 offen offset:1920 sc1
    v_cvt_pk_bf16_f32 v144, v80, v81
    v_cvt_pk_bf16_f32 v145, v82, v83
    v_cvt_pk_bf16_f32 v146, v84, v85
    v_cvt_pk_bf16_f32 v147, v86, v87
    buffer_store_dwordx4 v[144:147], v129, s[8:11], s61 offen offset:0 sc1
    v_cvt_pk_bf16_f32 v148, v88, v89
    v_cvt_pk_bf16_f32 v149, v90, v91
    v_cvt_pk_bf16_f32 v150, v92, v93
    v_cvt_pk_bf16_f32 v151, v94, v95
    buffer_store_dwordx4 v[148:151], v129, s[8:11], s61 offen offset:640 sc1
    v_cvt_pk_bf16_f32 v152, v112, v113
    v_cvt_pk_bf16_f32 v153, v114, v115
    v_cvt_pk_bf16_f32 v154, v116, v117
    v_cvt_pk_bf16_f32 v155, v118, v119
    buffer_store_dwordx4 v[152:155], v129, s[8:11], s61 offen offset:1280 sc1
    v_cvt_pk_bf16_f32 v156, v120, v121
    v_cvt_pk_bf16_f32 v157, v122, v123
    v_cvt_pk_bf16_f32 v158, v124, v125
    v_cvt_pk_bf16_f32 v159, v126, v127
    buffer_store_dwordx4 v[156:159], v129, s[8:11], s61 offen offset:1920 sc1
    s_cmp_eq_u32 s63, 1
    s_cbranch_scc1 concat_heads__linear_kernel_hedgehog__mha_block__prompt_kernel_kN_fin
    s_mov_b32 s63, 1
    s_sub_u32 s61, s61, 0x1000000
    s_mov_b32 s62, 1.0
    v_mov_b32 v64, 0
    v_mov_b32 v65, 0
    v_mov_b32 v66, 0
    v_mov_b32 v67, 0
    v_mov_b32 v68, 0
    v_mov_b32 v69, 0
    v_mov_b32 v70, 0
    v_mov_b32 v71, 0
    v_mov_b32 v72, 0
    v_mov_b32 v73, 0
    v_mov_b32 v74, 0
    v_mov_b32 v75, 0
    v_mov_b32 v76, 0
    v_mov_b32 v77, 0
    v_mov_b32 v78, 0
    v_mov_b32 v79, 0
    v_mov_b32 v80, 0
    v_mov_b32 v81, 0
    v_mov_b32 v82, 0
    v_mov_b32 v83, 0
    v_mov_b32 v84, 0
    v_mov_b32 v85, 0
    v_mov_b32 v86, 0
    v_mov_b32 v87, 0
    v_mov_b32 v88, 0
    v_mov_b32 v89, 0
    v_mov_b32 v90, 0
    v_mov_b32 v91, 0
    v_mov_b32 v92, 0
    v_mov_b32 v93, 0
    v_mov_b32 v94, 0
    v_mov_b32 v95, 0
    v_mov_b32 v96, 0
    v_mov_b32 v97, 0
    v_mov_b32 v98, 0
    v_mov_b32 v99, 0
    v_mov_b32 v100, 0
    v_mov_b32 v101, 0
    v_mov_b32 v102, 0
    v_mov_b32 v103, 0
    v_mov_b32 v104, 0
    v_mov_b32 v105, 0
    v_mov_b32 v106, 0
    v_mov_b32 v107, 0
    v_mov_b32 v108, 0
    v_mov_b32 v109, 0
    v_mov_b32 v110, 0
    v_mov_b32 v111, 0
    v_mov_b32 v112, 0
    v_mov_b32 v113, 0
    v_mov_b32 v114, 0
    v_mov_b32 v115, 0
    v_mov_b32 v116, 0
    v_mov_b32 v117, 0
    v_mov_b32 v118, 0
    v_mov_b32 v119, 0
    v_mov_b32 v120, 0
    v_mov_b32 v121, 0
    v_mov_b32 v122, 0
    v_mov_b32 v123, 0
    v_mov_b32 v124, 0
    v_mov_b32 v125, 0
    v_mov_b32 v126, 0
    v_mov_b32 v127, 0
    s_branch concat_heads__linear_kernel_hedgehog__mha_block__prompt_kernel_kN_epir
concat_heads__linear_kernel_hedgehog__mha_block__prompt_kernel_kN_fin:
    s_mul_i32 s55, s32, 3
    s_add_u32 s55, s55, 0
    s_min_u32 s55, s55, 21
    s_cmp_ge_u32 s55, 11
    s_cselect_b32 s56, 1, 0
    s_mul_i32 s57, s56, 11
    s_sub_u32 s55, s55, s57
    s_mul_i32 s57, s56, 11264
    s_lshl_b32 s58, s55, 10
    s_add_u32 s50, s57, s58
    s_lshl_b32 s56, s56, 3
    s_cmp_ge_u32 s55, 6
    s_cbranch_scc1 kd_7_v
    s_lshr_b32 s57, s55, 1
    s_add_u32 s58, s66, s57
    s_cmp_eq_u32 s57, 2
    s_cselect_b32 s58, s67, s58
    s_add_u32 s58, s58, 80
    s_lshl_b32 s58, s58, 15
    s_lshl_b32 s56, s56, 11
    s_add_u32 s58, s58, s56
    s_and_b32 s57, s55, 1
    s_lshl_b32 s57, s57, 10
    s_add_u32 s58, s58, s57
    s_add_u32 s44, s58, 16777216
    s_mov_b32 s47, 2048
    s_branch kd_7_e
kd_7_v:
    s_mul_i32 s56, s56, 5120
    s_sub_u32 s57, s55, 6
    s_lshl_b32 s57, s57, 10
    s_add_u32 s56, s56, s57
    s_add_u32 s44, s56, s53
    s_mov_b32 s47, 5120
kd_7_e:
    s_add_u32 s44, s44, s47
    s_mul_i32 s55, s32, 3
    s_add_u32 s55, s55, 1
    s_min_u32 s55, s55, 21
    s_cmp_ge_u32 s55, 11
    s_cselect_b32 s56, 1, 0
    s_mul_i32 s57, s56, 11
    s_sub_u32 s55, s55, s57
    s_mul_i32 s57, s56, 11264
    s_lshl_b32 s58, s55, 10
    s_add_u32 s51, s57, s58
    s_lshl_b32 s56, s56, 3
    s_cmp_ge_u32 s55, 6
    s_cbranch_scc1 kd_8_v
    s_lshr_b32 s57, s55, 1
    s_add_u32 s58, s66, s57
    s_cmp_eq_u32 s57, 2
    s_cselect_b32 s58, s67, s58
    s_add_u32 s58, s58, 80
    s_lshl_b32 s58, s58, 15
    s_lshl_b32 s56, s56, 11
    s_add_u32 s58, s58, s56
    s_and_b32 s57, s55, 1
    s_lshl_b32 s57, s57, 10
    s_add_u32 s58, s58, s57
    s_add_u32 s45, s58, 16777216
    s_mov_b32 s48, 2048
    s_branch kd_8_e
kd_8_v:
    s_mul_i32 s56, s56, 5120
    s_sub_u32 s57, s55, 6
    s_lshl_b32 s57, s57, 10
    s_add_u32 s56, s56, s57
    s_add_u32 s45, s56, s53
    s_mov_b32 s48, 5120
kd_8_e:
    s_add_u32 s45, s45, s48
    s_mul_i32 s55, s32, 3
    s_add_u32 s55, s55, 2
    s_min_u32 s55, s55, 21
    s_cmp_ge_u32 s55, 11
    s_cselect_b32 s56, 1, 0
    s_mul_i32 s57, s56, 11
    s_sub_u32 s55, s55, s57
    s_mul_i32 s57, s56, 11264
    s_lshl_b32 s58, s55, 10
    s_add_u32 s52, s57, s58
    s_lshl_b32 s56, s56, 3
    s_cmp_ge_u32 s55, 6
    s_cbranch_scc1 kd_9_v
    s_lshr_b32 s57, s55, 1
    s_add_u32 s58, s66, s57
    s_cmp_eq_u32 s57, 2
    s_cselect_b32 s58, s67, s58
    s_add_u32 s58, s58, 80
    s_lshl_b32 s58, s58, 15
    s_lshl_b32 s56, s56, 11
    s_add_u32 s58, s58, s56
    s_and_b32 s57, s55, 1
    s_lshl_b32 s57, s57, 10
    s_add_u32 s58, s58, s57
    s_add_u32 s46, s58, 16777216
    s_mov_b32 s49, 2048
    s_branch kd_9_e
kd_9_v:
    s_mul_i32 s56, s56, 5120
    s_sub_u32 s57, s55, 6
    s_lshl_b32 s57, s57, 10
    s_add_u32 s56, s56, s57
    s_add_u32 s46, s56, s53
    s_mov_b32 s49, 5120
kd_9_e:
    s_add_u32 s46, s46, s49
    s_branch concat_heads__linear_kernel_hedgehog__mha_block__prompt_kernel_cdone
concat_heads__linear_kernel_hedgehog__mha_block__prompt_kernel_kN_vm:
    s_waitcnt vmcnt(0)
    s_branch concat_heads__linear_kernel_hedgehog__mha_block__prompt_kernel_kN_vmr
concat_heads__linear_kernel_hedgehog__mha_block__prompt_kernel_kN_fp:
    s_cmp_eq_u32 s32, 0
    s_cbranch_scc0 concat_heads__linear_kernel_hedgehog__mha_block__prompt_kernel_kN_fpr
    v_mov_b32 v160, 124
    global_load_dword v161, v160, s[4:5] sc1
    s_branch concat_heads__linear_kernel_hedgehog__mha_block__prompt_kernel_kN_fpr
concat_heads__linear_kernel_hedgehog__mha_block__prompt_kernel_kN_sig:
    s_cmp_eq_u32 s32, 0
    s_cbranch_scc0 concat_heads__linear_kernel_hedgehog__mha_block__prompt_kernel_kN_sigr
    v_readfirstlane_b32 s58, v161
    s_cmp_ge_u32 s58, 16
    s_cbranch_scc1 cp_10
    v_mov_b32 v160, 124
    global_load_dword v161, v160, s[4:5] sc1
    s_mov_b32 s59, 0
cp_11:
    s_waitcnt vmcnt(0)
    v_readfirstlane_b32 s58, v161
    s_cmp_ge_u32 s58, 16
    s_cbranch_scc1 cp_11_ok
    s_sleep 16
    global_load_dword v161, v160, s[4:5] sc1
    s_add_u32 s59, s59, 1
    s_cmp_lt_u32 s59, 50000
    s_cbranch_scc1 cp_11
cp_11_ok:
cp_10:
    s_lshl_b32 s54, s38, 7
    s_lshl_b32 s55, s37, 2
    s_add_u32 s54, s54, s55
    s_add_u32 s54, s54, 13778944
    v_mov_b32 v160, 0
    v_mov_b32 v161, 1
    s_mov_b64 exec, 1
    buffer_store_dword v161, v160, s[8:11], s54 offen sc1
    s_mov_b64 exec, -1
    s_branch concat_heads__linear_kernel_hedgehog__mha_block__prompt_kernel_kN_sigr
concat_heads__linear_kernel_hedgehog__mha_block__prompt_kernel_cdone:
    s_barrier
    s_branch concat_heads__linear_kernel_hedgehog__mha_block__prompt_kernel_p2entry
concat_heads__linear_kernel_hedgehog__mha_block__prompt_kernel_prep:
    s_lshl_b32 s69, s65, 2
    s_add_u32 s69, s69, s64
    s_sub_u32 s69, s69, 28
    s_cmp_ge_u32 s32, 3
    s_cbranch_scc1 concat_heads__linear_kernel_hedgehog__mha_block__prompt_kernel_prep_done
    s_mov_b32 s12, s28
    s_and_b32 s13, s29, 0xffff
    s_mov_b32 s14, 0x6400
    s_mov_b32 s15, 0x20000
    s_cmp_eq_u32 s32, 2
    s_cbranch_scc1 concat_heads__linear_kernel_hedgehog__mha_block__prompt_kernel_sel
    s_lshl_b32 s44, s69, 1
    s_add_u32 s44, s44, s32
    v_subrev_u32 v4, 2, v3
    v_cmp_gt_u32 vcc, 18, v3
    s_nop 1
    v_cndmask_b32 v4, v4, v3, vcc
    v_and_b32 v5, 30, v3
    v_cmp_eq_u32 s[46:47], 20, v5
    s_or_b64 s[46:47], s[46:47], vcc
    v_lshlrev_b32 v4, 1, v4
    s_mul_i32 s45, s44, 800
    v_add_u32 v4, s45, v4
    s_and_b32 s45, s44, 1
    s_mul_i32 s48, s45, 160
    v_mul_u32_u24 v5, 320, v131
    v_add3_u32 v5, v4, v5, s48
    v_mov_b32 v6, 0x7fffffff
    v_cndmask_b32 v5, v6, v5, s[46:47]
    v_cmp_eq_u32 vcc, 0, v131
    s_and_b64 s[46:47], s[46:47], vcc
    s_cmp_eq_u32 s45, 1
    s_cselect_b32 s48, 0, 640
    v_add_u32 v4, s48, v4
    v_cndmask_b32 v4, v6, v4, s[46:47]
    buffer_load_ushort v16, v5, s[12:15], 0 offen offset:0
    buffer_load_ushort v17, v5, s[12:15], 0 offen offset:40
    buffer_load_ushort v18, v5, s[12:15], 0 offen offset:80
    buffer_load_ushort v19, v5, s[12:15], 0 offen offset:120
    buffer_load_ushort v20, v5, s[12:15], 0 offen offset:160
    buffer_load_ushort v21, v5, s[12:15], 0 offen offset:200
    buffer_load_ushort v22, v5, s[12:15], 0 offen offset:240
    buffer_load_ushort v23, v5, s[12:15], 0 offen offset:280
    buffer_load_ushort v24, v4, s[12:15], 0 offen offset:0
    buffer_load_ushort v25, v4, s[12:15], 0 offen offset:40
    buffer_load_ushort v26, v4, s[12:15], 0 offen offset:80
    buffer_load_ushort v27, v4, s[12:15], 0 offen offset:120
    s_waitcnt vmcnt(0)
    v_lshlrev_b32 v16, 16, v16
    v_mul_f32 v16, 0x3fb8aa3b, v16
    v_lshlrev_b32 v17, 16, v17
    v_mul_f32 v17, 0x3fb8aa3b, v17
    v_lshlrev_b32 v18, 16, v18
    v_mul_f32 v18, 0x3fb8aa3b, v18
    v_lshlrev_b32 v19, 16, v19
    v_mul_f32 v19, 0x3fb8aa3b, v19
    v_lshlrev_b32 v20, 16, v20
    v_mul_f32 v20, 0x3fb8aa3b, v20
    v_lshlrev_b32 v21, 16, v21
    v_mul_f32 v21, 0x3fb8aa3b, v21
    v_lshlrev_b32 v22, 16, v22
    v_mul_f32 v22, 0x3fb8aa3b, v22
    v_lshlrev_b32 v23, 16, v23
    v_mul_f32 v23, 0x3fb8aa3b, v23
    v_lshlrev_b32 v24, 16, v24
    v_mul_f32 v24, 0x3fb8aa3b, v24
    v_lshlrev_b32 v25, 16, v25
    v_mul_f32 v25, 0x3fb8aa3b, v25
    v_lshlrev_b32 v26, 16, v26
    v_mul_f32 v26, 0x3fb8aa3b, v26
    v_lshlrev_b32 v27, 16, v27
    v_mul_f32 v27, 0x3fb8aa3b, v27
    v_cvt_pk_bf16_f32 v32, v16, v17
    v_cvt_pk_bf16_f32 v33, v18, v19
    v_cvt_pk_bf16_f32 v34, v20, v21
    v_cvt_pk_bf16_f32 v35, v22, v23
    v_cvt_pk_bf16_f32 v36, v24, v25
    v_cvt_pk_bf16_f32 v37, v26, v27
    s_mul_i32 s45, s44, 1536
    s_add_u32 s45, s45, 13631488
    v_lshlrev_b32 v7, 3, v1
    buffer_store_dwordx4 v[32:35], v2, s[8:11], s45 offen sc1
    buffer_store_dwordx2 v[36:37], v7, s[8:11], s45 offen offset:1024 sc1
    s_branch concat_heads__linear_kernel_hedgehog__mha_block__prompt_kernel_prep_done
concat_heads__linear_kernel_hedgehog__mha_block__prompt_kernel_sel:
    s_cmp_lg_u32 s69, 0
    s_cbranch_scc1 concat_heads__linear_kernel_hedgehog__mha_block__prompt_kernel_prep_done
    v_lshlrev_b32 v4, 2, v131
    v_sub_u32 v4, v3, v4
    v_cmp_eq_u32 vcc, 0, v4
    v_mov_b32 v5, 0x3f80
    s_nop 0
    v_cndmask_b32 v16, 0, v5, vcc
    v_cmp_eq_u32 vcc, 1, v4
    v_mov_b32 v5, 0x3f80
    s_nop 0
    v_cndmask_b32 v17, 0, v5, vcc
    v_cmp_eq_u32 vcc, 2, v4
    v_mov_b32 v5, 0x3f80
    s_nop 0
    v_cndmask_b32 v18, 0, v5, vcc
    v_cmp_eq_u32 vcc, 3, v4
    v_mov_b32 v5, 0x3f80
    s_nop 0
    v_cndmask_b32 v19, 0, v5, vcc
    v_cmp_eq_u32 vcc, 8, v4
    v_mov_b32 v5, 0x3f80
    s_nop 0
    v_cndmask_b32 v20, 0, v5, vcc
    v_cmp_eq_u32 vcc, 9, v4
    v_mov_b32 v5, 0x3f80
    s_nop 0
    v_cndmask_b32 v21, 0, v5, vcc
    v_cmp_eq_u32 vcc, 10, v4
    v_mov_b32 v5, 0x3f80
    s_nop 0
    v_cndmask_b32 v22, 0, v5, vcc
    v_cmp_eq_u32 vcc, 11, v4
    v_mov_b32 v5, 0x3f80
    s_nop 0
    v_cndmask_b32 v23, 0, v5, vcc
    v_cmp_eq_u32 vcc, 16, v4
    v_mov_b32 v5, 0x3f80
    s_nop 0
    v_cndmask_b32 v24, 0, v5, vcc
    v_cmp_eq_u32 vcc, 17, v4
    v_mov_b32 v5, 0x3f80
    s_nop 0
    v_cndmask_b32 v25, 0, v5, vcc
    v_cmp_eq_u32 vcc, 18, v4
    v_mov_b32 v5, 0x3f80
    s_nop 0
    v_cndmask_b32 v26, 0, v5, vcc
    v_cmp_eq_u32 vcc, 19, v4
    v_mov_b32 v5, 0x3f80
    s_nop 0
    v_cndmask_b32 v27, 0, v5, vcc
    v_lshl_or_b32 v32, v17, 16, v16
    v_lshl_or_b32 v33, v19, 16, v18
    v_lshl_or_b32 v34, v21, 16, v20
    v_lshl_or_b32 v35, v23, 16, v22
    v_lshl_or_b32 v36, v25, 16, v24
    v_lshl_or_b32 v37, v27, 16, v26
    s_mov_b32 s45, 13697024
    v_lshlrev_b32 v7, 3, v1
    buffer_store_dwordx4 v[32:35], v2, s[8:11], s45 offen sc1
    buffer_store_dwordx2 v[36:37], v7, s[8:11], s45 offen offset:1024 sc1
    v_mov_b32 v40, 0
    v_mov_b32 v41, 0
    v_mov_b32 v42, 0
    v_mov_b32 v43, 0
    s_mov_b32 s45, 13762560
    buffer_store_dwordx4 v[40:43], v2, s[8:11], s45 offen sc1
    s_mov_b32 s45, 13763584
    buffer_store_dwordx4 v[40:43], v2, s[8:11], s45 offen sc1
    s_mov_b32 s45, 13764608
    buffer_store_dwordx4 v[40:43], v2, s[8:11], s45 offen sc1
    s_mov_b32 s45, 13765632
    buffer_store_dwordx4 v[40:43], v2, s[8:11], s45 offen sc1
    s_mov_b32 s45, 13766656
    buffer_store_dwordx4 v[40:43], v2, s[8:11], s45 offen sc1
    s_mov_b32 s45, 13767680
    buffer_store_dwordx4 v[40:43], v2, s[8:11], s45 offen sc1
    s_mov_b32 s45, 13768704
    buffer_store_dwordx4 v[40:43], v2, s[8:11], s45 offen sc1
    s_mov_b32 s45, 13769728
    buffer_store_dwordx4 v[40:43], v2, s[8:11], s45 offen sc1
    s_mov_b32 s45, 13770752
    buffer_store_dwordx4 v[40:43], v2, s[8:11], s45 offen sc1
    s_mov_b32 s45, 13771776
    buffer_store_dwordx4 v[40:43], v2, s[8:11], s45 offen sc1
    s_mov_b32 s45, 13772800
    buffer_store_dwordx4 v[40:43], v2, s[8:11], s45 offen sc1
    s_mov_b32 s45, 13773824
    buffer_store_dwordx4 v[40:43], v2, s[8:11], s45 offen sc1
    s_mov_b32 s45, 13774848
    buffer_store_dwordx4 v[40:43], v2, s[8:11], s45 offen sc1
    s_mov_b32 s45, 13775872
    buffer_store_dwordx4 v[40:43], v2, s[8:11], s45 offen sc1
    s_mov_b32 s45, 13776896
    buffer_store_dwordx4 v[40:43], v2, s[8:11], s45 offen sc1
    s_mov_b32 s45, 13777920
    buffer_store_dwordx4 v[40:43], v2, s[8:11], s45 offen sc1
    s_mov_b32 s45, 13778944
    buffer_store_dwordx4 v[40:43], v2, s[8:11], s45 offen sc1
    s_mov_b32 s45, 13779968
    buffer_store_dwordx4 v[40:43], v2, s[8:11], s45 offen sc1
    s_mov_b32 s45, 13780992
    buffer_store_dwordx4 v[40:43], v2, s[8:11], s45 offen sc1
    s_mov_b32 s45, 13782016
    buffer_store_dwordx4 v[40:43], v2, s[8:11], s45 offen sc1
    s_mov_b32 s45, 13783040
    buffer_store_dwordx4 v[40:43], v2, s[8:11], s45 offen sc1
    s_mov_b32 s45, 13784064
    buffer_store_dwordx4 v[40:43], v2, s[8:11], s45 offen sc1
    s_mov_b32 s45, 13785088
    buffer_store_dwordx4 v[40:43], v2, s[8:11], s45 offen sc1
    s_mov_b32 s45, 13786112
    buffer_store_dwordx4 v[40:43], v2, s[8:11], s45 offen sc1
    s_mov_b32 s45, 13787136
    buffer_store_dwordx4 v[40:43], v2, s[8:11], s45 offen sc1
    s_mov_b32 s45, 13788160
    buffer_store_dwordx4 v[40:43], v2, s[8:11], s45 offen sc1
    s_mov_b32 s45, 13789184
    buffer_store_dwordx4 v[40:43], v2, s[8:11], s45 offen sc1
    s_mov_b32 s45, 13790208
    buffer_store_dwordx4 v[40:43], v2, s[8:11], s45 offen sc1
    s_mov_b32 s45, 13791232
    buffer_store_dwordx4 v[40:43], v2, s[8:11], s45 offen sc1
    s_mov_b32 s45, 13792256
    buffer_store_dwordx4 v[40:43], v2, s[8:11], s45 offen sc1
    s_mov_b32 s45, 13793280
    buffer_store_dwordx4 v[40:43], v2, s[8:11], s45 offen sc1
    s_mov_b32 s45, 13794304
    buffer_store_dwordx4 v[40:43], v2, s[8:11], s45 offen sc1
concat_heads__linear_kernel_hedgehog__mha_block__prompt_kernel_prep_done:
    s_load_dwordx2 s[44:45], s[0:1], 24
    s_load_dwordx2 s[46:47], s[0:1], 48
    s_waitcnt lgkmcnt(0)
    s_mov_b32 s12, s44
    s_and_b32 s13, s45, 0xffff
    s_mov_b32 s14, 0xc8000
    s_mov_b32 s15, 0x20000
    s_mov_b32 s16, s46
    s_and_b32 s17, s47, 0xffff
    s_mov_b32 s18, 0xc8000
    s_mov_b32 s19, 0x20000
    s_add_u32 s48, s32, 0
    s_cmp_ge_u32 s48, 100
    s_cbranch_scc1 wr_12
    s_mul_i32 s49, s48, 205
    s_lshr_b32 s49, s49, 11
    s_mul_i32 s50, s49, 10
    s_sub_u32 s50, s48, s50
    s_mul_i32 s51, s69, 10
    s_add_u32 s49, s49, s51
    s_lshl_b32 s50, s50, 6
    v_add_u32 v10, s50, v1
    v_lshrrev_b32 v11, 5, v10
    v_mul_u32_u24 v12, 205, v11
    v_lshrrev_b32 v12, 11, v12
    v_mul_u32_u24 v13, 10, v12
    v_sub_u32 v11, v11, v13
    v_mul_u32_u24 v13, 52, v11
    v_lshrrev_b32 v13, 8, v13
    v_mul_u32_u24 v14, 5, v13
    v_sub_u32 v11, v11, v14
    v_lshlrev_b32 v12, 5, v12
    v_lshlrev_b32 v13, 2, v13
    v_add_u32 v12, v12, v13
    v_lshrrev_b32 v13, 3, v10
    v_and_b32 v13, 3, v13
    v_lshlrev_b32 v13, 3, v13
    v_add_u32 v12, v12, v13
    v_lshrrev_b32 v13, 1, v10
    v_and_b32 v13, 3, v13
    v_add_u32 v12, v12, v13
    v_mul_u32_u24 v12, 1280, v12
    v_lshlrev_b32 v11, 5, v11
    v_and_b32 v13, 1, v10
    v_lshlrev_b32 v13, 4, v13
    v_add3_u32 v10, v12, v11, v13
    s_cmp_ge_u32 s49, 80
    s_cselect_b32 s51, 80, 0
    s_sub_u32 s51, s49, s51
    s_mul_i32 s52, s51, 205
    s_lshr_b32 s52, s52, 11
    s_mul_i32 s54, s52, 10
    s_sub_u32 s54, s51, s54
    s_mul_i32 s54, s54, 81920
    s_mul_i32 s52, s52, 160
    s_add_u32 s54, s54, s52
    s_cmp_ge_u32 s49, 80
    s_cbranch_scc1 wr_12_b
    buffer_load_dwordx4 v[64:67], v10, s[12:15], s54 offen
    s_branch wr_12
wr_12_b:
    buffer_load_dwordx4 v[64:67], v10, s[16:19], s54 offen
wr_12:
    s_add_u32 s48, s32, 8
    s_cmp_ge_u32 s48, 100
    s_cbranch_scc1 wr_13
    s_mul_i32 s49, s48, 205
    s_lshr_b32 s49, s49, 11
    s_mul_i32 s50, s49, 10
    s_sub_u32 s50, s48, s50
    s_mul_i32 s51, s69, 10
    s_add_u32 s49, s49, s51
    s_lshl_b32 s50, s50, 6
    v_add_u32 v10, s50, v1
    v_lshrrev_b32 v11, 5, v10
    v_mul_u32_u24 v12, 205, v11
    v_lshrrev_b32 v12, 11, v12
    v_mul_u32_u24 v13, 10, v12
    v_sub_u32 v11, v11, v13
    v_mul_u32_u24 v13, 52, v11
    v_lshrrev_b32 v13, 8, v13
    v_mul_u32_u24 v14, 5, v13
    v_sub_u32 v11, v11, v14
    v_lshlrev_b32 v12, 5, v12
    v_lshlrev_b32 v13, 2, v13
    v_add_u32 v12, v12, v13
    v_lshrrev_b32 v13, 3, v10
    v_and_b32 v13, 3, v13
    v_lshlrev_b32 v13, 3, v13
    v_add_u32 v12, v12, v13
    v_lshrrev_b32 v13, 1, v10
    v_and_b32 v13, 3, v13
    v_add_u32 v12, v12, v13
    v_mul_u32_u24 v12, 1280, v12
    v_lshlrev_b32 v11, 5, v11
    v_and_b32 v13, 1, v10
    v_lshlrev_b32 v13, 4, v13
    v_add3_u32 v10, v12, v11, v13
    s_cmp_ge_u32 s49, 80
    s_cselect_b32 s51, 80, 0
    s_sub_u32 s51, s49, s51
    s_mul_i32 s52, s51, 205
    s_lshr_b32 s52, s52, 11
    s_mul_i32 s54, s52, 10
    s_sub_u32 s54, s51, s54
    s_mul_i32 s54, s54, 81920
    s_mul_i32 s52, s52, 160
    s_add_u32 s54, s54, s52
    s_cmp_ge_u32 s49, 80
    s_cbranch_scc1 wr_13_b
    buffer_load_dwordx4 v[68:71], v10, s[12:15], s54 offen
    s_branch wr_13
wr_13_b:
    buffer_load_dwordx4 v[68:71], v10, s[16:19], s54 offen
wr_13:
    s_add_u32 s48, s32, 16
    s_cmp_ge_u32 s48, 100
    s_cbranch_scc1 wr_14
    s_mul_i32 s49, s48, 205
    s_lshr_b32 s49, s49, 11
    s_mul_i32 s50, s49, 10
    s_sub_u32 s50, s48, s50
    s_mul_i32 s51, s69, 10
    s_add_u32 s49, s49, s51
    s_lshl_b32 s50, s50, 6
    v_add_u32 v10, s50, v1
    v_lshrrev_b32 v11, 5, v10
    v_mul_u32_u24 v12, 205, v11
    v_lshrrev_b32 v12, 11, v12
    v_mul_u32_u24 v13, 10, v12
    v_sub_u32 v11, v11, v13
    v_mul_u32_u24 v13, 52, v11
    v_lshrrev_b32 v13, 8, v13
    v_mul_u32_u24 v14, 5, v13
    v_sub_u32 v11, v11, v14
    v_lshlrev_b32 v12, 5, v12
    v_lshlrev_b32 v13, 2, v13
    v_add_u32 v12, v12, v13
    v_lshrrev_b32 v13, 3, v10
    v_and_b32 v13, 3, v13
    v_lshlrev_b32 v13, 3, v13
    v_add_u32 v12, v12, v13
    v_lshrrev_b32 v13, 1, v10
    v_and_b32 v13, 3, v13
    v_add_u32 v12, v12, v13
    v_mul_u32_u24 v12, 1280, v12
    v_lshlrev_b32 v11, 5, v11
    v_and_b32 v13, 1, v10
    v_lshlrev_b32 v13, 4, v13
    v_add3_u32 v10, v12, v11, v13
    s_cmp_ge_u32 s49, 80
    s_cselect_b32 s51, 80, 0
    s_sub_u32 s51, s49, s51
    s_mul_i32 s52, s51, 205
    s_lshr_b32 s52, s52, 11
    s_mul_i32 s54, s52, 10
    s_sub_u32 s54, s51, s54
    s_mul_i32 s54, s54, 81920
    s_mul_i32 s52, s52, 160
    s_add_u32 s54, s54, s52
    s_cmp_ge_u32 s49, 80
    s_cbranch_scc1 wr_14_b
    buffer_load_dwordx4 v[72:75], v10, s[12:15], s54 offen
    s_branch wr_14
wr_14_b:
    buffer_load_dwordx4 v[72:75], v10, s[16:19], s54 offen
wr_14:
    s_add_u32 s48, s32, 24
    s_cmp_ge_u32 s48, 100
    s_cbranch_scc1 wr_15
    s_mul_i32 s49, s48, 205
    s_lshr_b32 s49, s49, 11
    s_mul_i32 s50, s49, 10
    s_sub_u32 s50, s48, s50
    s_mul_i32 s51, s69, 10
    s_add_u32 s49, s49, s51
    s_lshl_b32 s50, s50, 6
    v_add_u32 v10, s50, v1
    v_lshrrev_b32 v11, 5, v10
    v_mul_u32_u24 v12, 205, v11
    v_lshrrev_b32 v12, 11, v12
    v_mul_u32_u24 v13, 10, v12
    v_sub_u32 v11, v11, v13
    v_mul_u32_u24 v13, 52, v11
    v_lshrrev_b32 v13, 8, v13
    v_mul_u32_u24 v14, 5, v13
    v_sub_u32 v11, v11, v14
    v_lshlrev_b32 v12, 5, v12
    v_lshlrev_b32 v13, 2, v13
    v_add_u32 v12, v12, v13
    v_lshrrev_b32 v13, 3, v10
    v_and_b32 v13, 3, v13
    v_lshlrev_b32 v13, 3, v13
    v_add_u32 v12, v12, v13
    v_lshrrev_b32 v13, 1, v10
    v_and_b32 v13, 3, v13
    v_add_u32 v12, v12, v13
    v_mul_u32_u24 v12, 1280, v12
    v_lshlrev_b32 v11, 5, v11
    v_and_b32 v13, 1, v10
    v_lshlrev_b32 v13, 4, v13
    v_add3_u32 v10, v12, v11, v13
    s_cmp_ge_u32 s49, 80
    s_cselect_b32 s51, 80, 0
    s_sub_u32 s51, s49, s51
    s_mul_i32 s52, s51, 205
    s_lshr_b32 s52, s52, 11
    s_mul_i32 s54, s52, 10
    s_sub_u32 s54, s51, s54
    s_mul_i32 s54, s54, 81920
    s_mul_i32 s52, s52, 160
    s_add_u32 s54, s54, s52
    s_cmp_ge_u32 s49, 80
    s_cbranch_scc1 wr_15_b
    buffer_load_dwordx4 v[76:79], v10, s[12:15], s54 offen
    s_branch wr_15
wr_15_b:
    buffer_load_dwordx4 v[76:79], v10, s[16:19], s54 offen
wr_15:
    s_add_u32 s48, s32, 32
    s_cmp_ge_u32 s48, 100
    s_cbranch_scc1 wr_16
    s_mul_i32 s49, s48, 205
    s_lshr_b32 s49, s49, 11
    s_mul_i32 s50, s49, 10
    s_sub_u32 s50, s48, s50
    s_mul_i32 s51, s69, 10
    s_add_u32 s49, s49, s51
    s_lshl_b32 s50, s50, 6
    v_add_u32 v10, s50, v1
    v_lshrrev_b32 v11, 5, v10
    v_mul_u32_u24 v12, 205, v11
    v_lshrrev_b32 v12, 11, v12
    v_mul_u32_u24 v13, 10, v12
    v_sub_u32 v11, v11, v13
    v_mul_u32_u24 v13, 52, v11
    v_lshrrev_b32 v13, 8, v13
    v_mul_u32_u24 v14, 5, v13
    v_sub_u32 v11, v11, v14
    v_lshlrev_b32 v12, 5, v12
    v_lshlrev_b32 v13, 2, v13
    v_add_u32 v12, v12, v13
    v_lshrrev_b32 v13, 3, v10
    v_and_b32 v13, 3, v13
    v_lshlrev_b32 v13, 3, v13
    v_add_u32 v12, v12, v13
    v_lshrrev_b32 v13, 1, v10
    v_and_b32 v13, 3, v13
    v_add_u32 v12, v12, v13
    v_mul_u32_u24 v12, 1280, v12
    v_lshlrev_b32 v11, 5, v11
    v_and_b32 v13, 1, v10
    v_lshlrev_b32 v13, 4, v13
    v_add3_u32 v10, v12, v11, v13
    s_cmp_ge_u32 s49, 80
    s_cselect_b32 s51, 80, 0
    s_sub_u32 s51, s49, s51
    s_mul_i32 s52, s51, 205
    s_lshr_b32 s52, s52, 11
    s_mul_i32 s54, s52, 10
    s_sub_u32 s54, s51, s54
    s_mul_i32 s54, s54, 81920
    s_mul_i32 s52, s52, 160
    s_add_u32 s54, s54, s52
    s_cmp_ge_u32 s49, 80
    s_cbranch_scc1 wr_16_b
    buffer_load_dwordx4 v[80:83], v10, s[12:15], s54 offen
    s_branch wr_16
wr_16_b:
    buffer_load_dwordx4 v[80:83], v10, s[16:19], s54 offen
wr_16:
    s_add_u32 s48, s32, 40
    s_cmp_ge_u32 s48, 100
    s_cbranch_scc1 wr_17
    s_mul_i32 s49, s48, 205
    s_lshr_b32 s49, s49, 11
    s_mul_i32 s50, s49, 10
    s_sub_u32 s50, s48, s50
    s_mul_i32 s51, s69, 10
    s_add_u32 s49, s49, s51
    s_lshl_b32 s50, s50, 6
    v_add_u32 v10, s50, v1
    v_lshrrev_b32 v11, 5, v10
    v_mul_u32_u24 v12, 205, v11
    v_lshrrev_b32 v12, 11, v12
    v_mul_u32_u24 v13, 10, v12
    v_sub_u32 v11, v11, v13
    v_mul_u32_u24 v13, 52, v11
    v_lshrrev_b32 v13, 8, v13
    v_mul_u32_u24 v14, 5, v13
    v_sub_u32 v11, v11, v14
    v_lshlrev_b32 v12, 5, v12
    v_lshlrev_b32 v13, 2, v13
    v_add_u32 v12, v12, v13
    v_lshrrev_b32 v13, 3, v10
    v_and_b32 v13, 3, v13
    v_lshlrev_b32 v13, 3, v13
    v_add_u32 v12, v12, v13
    v_lshrrev_b32 v13, 1, v10
    v_and_b32 v13, 3, v13
    v_add_u32 v12, v12, v13
    v_mul_u32_u24 v12, 1280, v12
    v_lshlrev_b32 v11, 5, v11
    v_and_b32 v13, 1, v10
    v_lshlrev_b32 v13, 4, v13
    v_add3_u32 v10, v12, v11, v13
    s_cmp_ge_u32 s49, 80
    s_cselect_b32 s51, 80, 0
    s_sub_u32 s51, s49, s51
    s_mul_i32 s52, s51, 205
    s_lshr_b32 s52, s52, 11
    s_mul_i32 s54, s52, 10
    s_sub_u32 s54, s51, s54
    s_mul_i32 s54, s54, 81920
    s_mul_i32 s52, s52, 160
    s_add_u32 s54, s54, s52
    s_cmp_ge_u32 s49, 80
    s_cbranch_scc1 wr_17_b
    buffer_load_dwordx4 v[84:87], v10, s[12:15], s54 offen
    s_branch wr_17
wr_17_b:
    buffer_load_dwordx4 v[84:87], v10, s[16:19], s54 offen
wr_17:
    s_add_u32 s48, s32, 48
    s_cmp_ge_u32 s48, 100
    s_cbranch_scc1 wr_18
    s_mul_i32 s49, s48, 205
    s_lshr_b32 s49, s49, 11
    s_mul_i32 s50, s49, 10
    s_sub_u32 s50, s48, s50
    s_mul_i32 s51, s69, 10
    s_add_u32 s49, s49, s51
    s_lshl_b32 s50, s50, 6
    v_add_u32 v10, s50, v1
    v_lshrrev_b32 v11, 5, v10
    v_mul_u32_u24 v12, 205, v11
    v_lshrrev_b32 v12, 11, v12
    v_mul_u32_u24 v13, 10, v12
    v_sub_u32 v11, v11, v13
    v_mul_u32_u24 v13, 52, v11
    v_lshrrev_b32 v13, 8, v13
    v_mul_u32_u24 v14, 5, v13
    v_sub_u32 v11, v11, v14
    v_lshlrev_b32 v12, 5, v12
    v_lshlrev_b32 v13, 2, v13
    v_add_u32 v12, v12, v13
    v_lshrrev_b32 v13, 3, v10
    v_and_b32 v13, 3, v13
    v_lshlrev_b32 v13, 3, v13
    v_add_u32 v12, v12, v13
    v_lshrrev_b32 v13, 1, v10
    v_and_b32 v13, 3, v13
    v_add_u32 v12, v12, v13
    v_mul_u32_u24 v12, 1280, v12
    v_lshlrev_b32 v11, 5, v11
    v_and_b32 v13, 1, v10
    v_lshlrev_b32 v13, 4, v13
    v_add3_u32 v10, v12, v11, v13
    s_cmp_ge_u32 s49, 80
    s_cselect_b32 s51, 80, 0
    s_sub_u32 s51, s49, s51
    s_mul_i32 s52, s51, 205
    s_lshr_b32 s52, s52, 11
    s_mul_i32 s54, s52, 10
    s_sub_u32 s54, s51, s54
    s_mul_i32 s54, s54, 81920
    s_mul_i32 s52, s52, 160
    s_add_u32 s54, s54, s52
    s_cmp_ge_u32 s49, 80
    s_cbranch_scc1 wr_18_b
    buffer_load_dwordx4 v[88:91], v10, s[12:15], s54 offen
    s_branch wr_18
wr_18_b:
    buffer_load_dwordx4 v[88:91], v10, s[16:19], s54 offen
wr_18:
    s_add_u32 s48, s32, 56
    s_cmp_ge_u32 s48, 100
    s_cbranch_scc1 wr_19
    s_mul_i32 s49, s48, 205
    s_lshr_b32 s49, s49, 11
    s_mul_i32 s50, s49, 10
    s_sub_u32 s50, s48, s50
    s_mul_i32 s51, s69, 10
    s_add_u32 s49, s49, s51
    s_lshl_b32 s50, s50, 6
    v_add_u32 v10, s50, v1
    v_lshrrev_b32 v11, 5, v10
    v_mul_u32_u24 v12, 205, v11
    v_lshrrev_b32 v12, 11, v12
    v_mul_u32_u24 v13, 10, v12
    v_sub_u32 v11, v11, v13
    v_mul_u32_u24 v13, 52, v11
    v_lshrrev_b32 v13, 8, v13
    v_mul_u32_u24 v14, 5, v13
    v_sub_u32 v11, v11, v14
    v_lshlrev_b32 v12, 5, v12
    v_lshlrev_b32 v13, 2, v13
    v_add_u32 v12, v12, v13
    v_lshrrev_b32 v13, 3, v10
    v_and_b32 v13, 3, v13
    v_lshlrev_b32 v13, 3, v13
    v_add_u32 v12, v12, v13
    v_lshrrev_b32 v13, 1, v10
    v_and_b32 v13, 3, v13
    v_add_u32 v12, v12, v13
    v_mul_u32_u24 v12, 1280, v12
    v_lshlrev_b32 v11, 5, v11
    v_and_b32 v13, 1, v10
    v_lshlrev_b32 v13, 4, v13
    v_add3_u32 v10, v12, v11, v13
    s_cmp_ge_u32 s49, 80
    s_cselect_b32 s51, 80, 0
    s_sub_u32 s51, s49, s51
    s_mul_i32 s52, s51, 205
    s_lshr_b32 s52, s52, 11
    s_mul_i32 s54, s52, 10
    s_sub_u32 s54, s51, s54
    s_mul_i32 s54, s54, 81920
    s_mul_i32 s52, s52, 160
    s_add_u32 s54, s54, s52
    s_cmp_ge_u32 s49, 80
    s_cbranch_scc1 wr_19_b
    buffer_load_dwordx4 v[92:95], v10, s[12:15], s54 offen
    s_branch wr_19
wr_19_b:
    buffer_load_dwordx4 v[92:95], v10, s[16:19], s54 offen
wr_19:
    s_add_u32 s48, s32, 64
    s_cmp_ge_u32 s48, 100
    s_cbranch_scc1 wr_20
    s_mul_i32 s49, s48, 205
    s_lshr_b32 s49, s49, 11
    s_mul_i32 s50, s49, 10
    s_sub_u32 s50, s48, s50
    s_mul_i32 s51, s69, 10
    s_add_u32 s49, s49, s51
    s_lshl_b32 s50, s50, 6
    v_add_u32 v10, s50, v1
    v_lshrrev_b32 v11, 5, v10
    v_mul_u32_u24 v12, 205, v11
    v_lshrrev_b32 v12, 11, v12
    v_mul_u32_u24 v13, 10, v12
    v_sub_u32 v11, v11, v13
    v_mul_u32_u24 v13, 52, v11
    v_lshrrev_b32 v13, 8, v13
    v_mul_u32_u24 v14, 5, v13
    v_sub_u32 v11, v11, v14
    v_lshlrev_b32 v12, 5, v12
    v_lshlrev_b32 v13, 2, v13
    v_add_u32 v12, v12, v13
    v_lshrrev_b32 v13, 3, v10
    v_and_b32 v13, 3, v13
    v_lshlrev_b32 v13, 3, v13
    v_add_u32 v12, v12, v13
    v_lshrrev_b32 v13, 1, v10
    v_and_b32 v13, 3, v13
    v_add_u32 v12, v12, v13
    v_mul_u32_u24 v12, 1280, v12
    v_lshlrev_b32 v11, 5, v11
    v_and_b32 v13, 1, v10
    v_lshlrev_b32 v13, 4, v13
    v_add3_u32 v10, v12, v11, v13
    s_cmp_ge_u32 s49, 80
    s_cselect_b32 s51, 80, 0
    s_sub_u32 s51, s49, s51
    s_mul_i32 s52, s51, 205
    s_lshr_b32 s52, s52, 11
    s_mul_i32 s54, s52, 10
    s_sub_u32 s54, s51, s54
    s_mul_i32 s54, s54, 81920
    s_mul_i32 s52, s52, 160
    s_add_u32 s54, s54, s52
    s_cmp_ge_u32 s49, 80
    s_cbranch_scc1 wr_20_b
    buffer_load_dwordx4 v[96:99], v10, s[12:15], s54 offen
    s_branch wr_20
wr_20_b:
    buffer_load_dwordx4 v[96:99], v10, s[16:19], s54 offen
wr_20:
    s_add_u32 s48, s32, 72
    s_cmp_ge_u32 s48, 100
    s_cbranch_scc1 wr_21
    s_mul_i32 s49, s48, 205
    s_lshr_b32 s49, s49, 11
    s_mul_i32 s50, s49, 10
    s_sub_u32 s50, s48, s50
    s_mul_i32 s51, s69, 10
    s_add_u32 s49, s49, s51
    s_lshl_b32 s50, s50, 6
    v_add_u32 v10, s50, v1
    v_lshrrev_b32 v11, 5, v10
    v_mul_u32_u24 v12, 205, v11
    v_lshrrev_b32 v12, 11, v12
    v_mul_u32_u24 v13, 10, v12
    v_sub_u32 v11, v11, v13
    v_mul_u32_u24 v13, 52, v11
    v_lshrrev_b32 v13, 8, v13
    v_mul_u32_u24 v14, 5, v13
    v_sub_u32 v11, v11, v14
    v_lshlrev_b32 v12, 5, v12
    v_lshlrev_b32 v13, 2, v13
    v_add_u32 v12, v12, v13
    v_lshrrev_b32 v13, 3, v10
    v_and_b32 v13, 3, v13
    v_lshlrev_b32 v13, 3, v13
    v_add_u32 v12, v12, v13
    v_lshrrev_b32 v13, 1, v10
    v_and_b32 v13, 3, v13
    v_add_u32 v12, v12, v13
    v_mul_u32_u24 v12, 1280, v12
    v_lshlrev_b32 v11, 5, v11
    v_and_b32 v13, 1, v10
    v_lshlrev_b32 v13, 4, v13
    v_add3_u32 v10, v12, v11, v13
    s_cmp_ge_u32 s49, 80
    s_cselect_b32 s51, 80, 0
    s_sub_u32 s51, s49, s51
    s_mul_i32 s52, s51, 205
    s_lshr_b32 s52, s52, 11
    s_mul_i32 s54, s52, 10
    s_sub_u32 s54, s51, s54
    s_mul_i32 s54, s54, 81920
    s_mul_i32 s52, s52, 160
    s_add_u32 s54, s54, s52
    s_cmp_ge_u32 s49, 80
    s_cbranch_scc1 wr_21_b
    buffer_load_dwordx4 v[100:103], v10, s[12:15], s54 offen
    s_branch wr_21
wr_21_b:
    buffer_load_dwordx4 v[100:103], v10, s[16:19], s54 offen
wr_21:
    s_add_u32 s48, s32, 80
    s_cmp_ge_u32 s48, 100
    s_cbranch_scc1 wr_22
    s_mul_i32 s49, s48, 205
    s_lshr_b32 s49, s49, 11
    s_mul_i32 s50, s49, 10
    s_sub_u32 s50, s48, s50
    s_mul_i32 s51, s69, 10
    s_add_u32 s49, s49, s51
    s_lshl_b32 s50, s50, 6
    v_add_u32 v10, s50, v1
    v_lshrrev_b32 v11, 5, v10
    v_mul_u32_u24 v12, 205, v11
    v_lshrrev_b32 v12, 11, v12
    v_mul_u32_u24 v13, 10, v12
    v_sub_u32 v11, v11, v13
    v_mul_u32_u24 v13, 52, v11
    v_lshrrev_b32 v13, 8, v13
    v_mul_u32_u24 v14, 5, v13
    v_sub_u32 v11, v11, v14
    v_lshlrev_b32 v12, 5, v12
    v_lshlrev_b32 v13, 2, v13
    v_add_u32 v12, v12, v13
    v_lshrrev_b32 v13, 3, v10
    v_and_b32 v13, 3, v13
    v_lshlrev_b32 v13, 3, v13
    v_add_u32 v12, v12, v13
    v_lshrrev_b32 v13, 1, v10
    v_and_b32 v13, 3, v13
    v_add_u32 v12, v12, v13
    v_mul_u32_u24 v12, 1280, v12
    v_lshlrev_b32 v11, 5, v11
    v_and_b32 v13, 1, v10
    v_lshlrev_b32 v13, 4, v13
    v_add3_u32 v10, v12, v11, v13
    s_cmp_ge_u32 s49, 80
    s_cselect_b32 s51, 80, 0
    s_sub_u32 s51, s49, s51
    s_mul_i32 s52, s51, 205
    s_lshr_b32 s52, s52, 11
    s_mul_i32 s54, s52, 10
    s_sub_u32 s54, s51, s54
    s_mul_i32 s54, s54, 81920
    s_mul_i32 s52, s52, 160
    s_add_u32 s54, s54, s52
    s_cmp_ge_u32 s49, 80
    s_cbranch_scc1 wr_22_b
    buffer_load_dwordx4 v[104:107], v10, s[12:15], s54 offen
    s_branch wr_22
wr_22_b:
    buffer_load_dwordx4 v[104:107], v10, s[16:19], s54 offen
wr_22:
    s_add_u32 s48, s32, 88
    s_cmp_ge_u32 s48, 100
    s_cbranch_scc1 wr_23
    s_mul_i32 s49, s48, 205
    s_lshr_b32 s49, s49, 11
    s_mul_i32 s50, s49, 10
    s_sub_u32 s50, s48, s50
    s_mul_i32 s51, s69, 10
    s_add_u32 s49, s49, s51
    s_lshl_b32 s50, s50, 6
    v_add_u32 v10, s50, v1
    v_lshrrev_b32 v11, 5, v10
    v_mul_u32_u24 v12, 205, v11
    v_lshrrev_b32 v12, 11, v12
    v_mul_u32_u24 v13, 10, v12
    v_sub_u32 v11, v11, v13
    v_mul_u32_u24 v13, 52, v11
    v_lshrrev_b32 v13, 8, v13
    v_mul_u32_u24 v14, 5, v13
    v_sub_u32 v11, v11, v14
    v_lshlrev_b32 v12, 5, v12
    v_lshlrev_b32 v13, 2, v13
    v_add_u32 v12, v12, v13
    v_lshrrev_b32 v13, 3, v10
    v_and_b32 v13, 3, v13
    v_lshlrev_b32 v13, 3, v13
    v_add_u32 v12, v12, v13
    v_lshrrev_b32 v13, 1, v10
    v_and_b32 v13, 3, v13
    v_add_u32 v12, v12, v13
    v_mul_u32_u24 v12, 1280, v12
    v_lshlrev_b32 v11, 5, v11
    v_and_b32 v13, 1, v10
    v_lshlrev_b32 v13, 4, v13
    v_add3_u32 v10, v12, v11, v13
    s_cmp_ge_u32 s49, 80
    s_cselect_b32 s51, 80, 0
    s_sub_u32 s51, s49, s51
    s_mul_i32 s52, s51, 205
    s_lshr_b32 s52, s52, 11
    s_mul_i32 s54, s52, 10
    s_sub_u32 s54, s51, s54
    s_mul_i32 s54, s54, 81920
    s_mul_i32 s52, s52, 160
    s_add_u32 s54, s54, s52
    s_cmp_ge_u32 s49, 80
    s_cbranch_scc1 wr_23_b
    buffer_load_dwordx4 v[108:111], v10, s[12:15], s54 offen
    s_branch wr_23
wr_23_b:
    buffer_load_dwordx4 v[108:111], v10, s[16:19], s54 offen
wr_23:
    s_add_u32 s48, s32, 96
    s_cmp_ge_u32 s48, 100
    s_cbranch_scc1 wr_24
    s_mul_i32 s49, s48, 205
    s_lshr_b32 s49, s49, 11
    s_mul_i32 s50, s49, 10
    s_sub_u32 s50, s48, s50
    s_mul_i32 s51, s69, 10
    s_add_u32 s49, s49, s51
    s_lshl_b32 s50, s50, 6
    v_add_u32 v10, s50, v1
    v_lshrrev_b32 v11, 5, v10
    v_mul_u32_u24 v12, 205, v11
    v_lshrrev_b32 v12, 11, v12
    v_mul_u32_u24 v13, 10, v12
    v_sub_u32 v11, v11, v13
    v_mul_u32_u24 v13, 52, v11
    v_lshrrev_b32 v13, 8, v13
    v_mul_u32_u24 v14, 5, v13
    v_sub_u32 v11, v11, v14
    v_lshlrev_b32 v12, 5, v12
    v_lshlrev_b32 v13, 2, v13
    v_add_u32 v12, v12, v13
    v_lshrrev_b32 v13, 3, v10
    v_and_b32 v13, 3, v13
    v_lshlrev_b32 v13, 3, v13
    v_add_u32 v12, v12, v13
    v_lshrrev_b32 v13, 1, v10
    v_and_b32 v13, 3, v13
    v_add_u32 v12, v12, v13
    v_mul_u32_u24 v12, 1280, v12
    v_lshlrev_b32 v11, 5, v11
    v_and_b32 v13, 1, v10
    v_lshlrev_b32 v13, 4, v13
    v_add3_u32 v10, v12, v11, v13
    s_cmp_ge_u32 s49, 80
    s_cselect_b32 s51, 80, 0
    s_sub_u32 s51, s49, s51
    s_mul_i32 s52, s51, 205
    s_lshr_b32 s52, s52, 11
    s_mul_i32 s54, s52, 10
    s_sub_u32 s54, s51, s54
    s_mul_i32 s54, s54, 81920
    s_mul_i32 s52, s52, 160
    s_add_u32 s54, s54, s52
    s_cmp_ge_u32 s49, 80
    s_cbranch_scc1 wr_24_b
    buffer_load_dwordx4 v[112:115], v10, s[12:15], s54 offen
    s_branch wr_24
wr_24_b:
    buffer_load_dwordx4 v[112:115], v10, s[16:19], s54 offen
wr_24:
    s_waitcnt vmcnt(0)
    s_add_u32 s48, s32, 0
    s_cmp_ge_u32 s48, 100
    s_cbranch_scc1 ws_25
    s_mul_i32 s49, s69, 100
    s_add_u32 s49, s49, s48
    s_lshl_b32 s49, s49, 10
    s_add_u32 s49, s49, 14680064
    buffer_store_dwordx4 v[64:67], v2, s[8:11], s49 offen sc1
ws_25:
    s_add_u32 s48, s32, 8
    s_cmp_ge_u32 s48, 100
    s_cbranch_scc1 ws_26
    s_mul_i32 s49, s69, 100
    s_add_u32 s49, s49, s48
    s_lshl_b32 s49, s49, 10
    s_add_u32 s49, s49, 14680064
    buffer_store_dwordx4 v[68:71], v2, s[8:11], s49 offen sc1
ws_26:
    s_add_u32 s48, s32, 16
    s_cmp_ge_u32 s48, 100
    s_cbranch_scc1 ws_27
    s_mul_i32 s49, s69, 100
    s_add_u32 s49, s49, s48
    s_lshl_b32 s49, s49, 10
    s_add_u32 s49, s49, 14680064
    buffer_store_dwordx4 v[72:75], v2, s[8:11], s49 offen sc1
ws_27:
    s_add_u32 s48, s32, 24
    s_cmp_ge_u32 s48, 100
    s_cbranch_scc1 ws_28
    s_mul_i32 s49, s69, 100
    s_add_u32 s49, s49, s48
    s_lshl_b32 s49, s49, 10
    s_add_u32 s49, s49, 14680064
    buffer_store_dwordx4 v[76:79], v2, s[8:11], s49 offen sc1
ws_28:
    s_add_u32 s48, s32, 32
    s_cmp_ge_u32 s48, 100
    s_cbranch_scc1 ws_29
    s_mul_i32 s49, s69, 100
    s_add_u32 s49, s49, s48
    s_lshl_b32 s49, s49, 10
    s_add_u32 s49, s49, 14680064
    buffer_store_dwordx4 v[80:83], v2, s[8:11], s49 offen sc1
ws_29:
    s_add_u32 s48, s32, 40
    s_cmp_ge_u32 s48, 100
    s_cbranch_scc1 ws_30
    s_mul_i32 s49, s69, 100
    s_add_u32 s49, s49, s48
    s_lshl_b32 s49, s49, 10
    s_add_u32 s49, s49, 14680064
    buffer_store_dwordx4 v[84:87], v2, s[8:11], s49 offen sc1
ws_30:
    s_add_u32 s48, s32, 48
    s_cmp_ge_u32 s48, 100
    s_cbranch_scc1 ws_31
    s_mul_i32 s49, s69, 100
    s_add_u32 s49, s49, s48
    s_lshl_b32 s49, s49, 10
    s_add_u32 s49, s49, 14680064
    buffer_store_dwordx4 v[88:91], v2, s[8:11], s49 offen sc1
ws_31:
    s_add_u32 s48, s32, 56
    s_cmp_ge_u32 s48, 100
    s_cbranch_scc1 ws_32
    s_mul_i32 s49, s69, 100
    s_add_u32 s49, s49, s48
    s_lshl_b32 s49, s49, 10
    s_add_u32 s49, s49, 14680064
    buffer_store_dwordx4 v[92:95], v2, s[8:11], s49 offen sc1
ws_32:
    s_add_u32 s48, s32, 64
    s_cmp_ge_u32 s48, 100
    s_cbranch_scc1 ws_33
    s_mul_i32 s49, s69, 100
    s_add_u32 s49, s49, s48
    s_lshl_b32 s49, s49, 10
    s_add_u32 s49, s49, 14680064
    buffer_store_dwordx4 v[96:99], v2, s[8:11], s49 offen sc1
ws_33:
    s_add_u32 s48, s32, 72
    s_cmp_ge_u32 s48, 100
    s_cbranch_scc1 ws_34
    s_mul_i32 s49, s69, 100
    s_add_u32 s49, s49, s48
    s_lshl_b32 s49, s49, 10
    s_add_u32 s49, s49, 14680064
    buffer_store_dwordx4 v[100:103], v2, s[8:11], s49 offen sc1
ws_34:
    s_add_u32 s48, s32, 80
    s_cmp_ge_u32 s48, 100
    s_cbranch_scc1 ws_35
    s_mul_i32 s49, s69, 100
    s_add_u32 s49, s49, s48
    s_lshl_b32 s49, s49, 10
    s_add_u32 s49, s49, 14680064
    buffer_store_dwordx4 v[104:107], v2, s[8:11], s49 offen sc1
ws_35:
    s_add_u32 s48, s32, 88
    s_cmp_ge_u32 s48, 100
    s_cbranch_scc1 ws_36
    s_mul_i32 s49, s69, 100
    s_add_u32 s49, s49, s48
    s_lshl_b32 s49, s49, 10
    s_add_u32 s49, s49, 14680064
    buffer_store_dwordx4 v[108:111], v2, s[8:11], s49 offen sc1
ws_36:
    s_add_u32 s48, s32, 96
    s_cmp_ge_u32 s48, 100
    s_cbranch_scc1 ws_37
    s_mul_i32 s49, s69, 100
    s_add_u32 s49, s49, s48
    s_lshl_b32 s49, s49, 10
    s_add_u32 s49, s49, 14680064
    buffer_store_dwordx4 v[112:115], v2, s[8:11], s49 offen sc1
ws_37:
    s_waitcnt vmcnt(0)
    s_cmp_eq_u32 s36, 0
    s_cbranch_scc0 concat_heads__linear_kernel_hedgehog__mha_block__prompt_kernel_prep_npf
concat_heads__linear_kernel_hedgehog__mha_block__prompt_kernel_prep_npf:
    s_barrier
    s_cmp_eq_u32 s32, 4
    s_cbranch_scc0 concat_heads__linear_kernel_hedgehog__mha_block__prompt_kernel_prep_w
    s_mov_b32 s50, 31
    s_lshl_b32 s58, s50, 2
    v_mov_b32 v48, s58
    v_mov_b32 v49, 1
    s_mov_b64 exec, 1
    global_atomic_add v48, v49, s[4:5] sc1
    s_mov_b64 exec, -1
    v_mov_b32 v48, 124
    global_load_dword v49, v48, s[4:5] sc1
    s_mov_b32 s59, 0
cp_38:
    s_waitcnt vmcnt(0)
    v_readfirstlane_b32 s58, v49
    s_cmp_ge_u32 s58, 16
    s_cbranch_scc1 cp_38_ok
    s_sleep 16
    global_load_dword v49, v48, s[4:5] sc1
    s_add_u32 s59, s59, 1
    s_cmp_lt_u32 s59, 50000
    s_cbranch_scc1 cp_38
cp_38_ok:
    s_mov_b32 s50, 13778944
    s_mul_i32 s56, s33, 20
    s_add_u32 s57, s56, 19
    s_lshr_b32 s56, s56, 7
    s_lshr_b32 s57, s57, 7
    v_lshrrev_b32 v7, 3, v1
    v_min_u32 v7, 2, v7
    v_mul_u32_u24 v7, 5, v7
    v_bfe_u32 v8, v1, 2, 1
    v_cmp_eq_u32 vcc, 1, v8
    v_mov_b32 v8, s56
    v_mov_b32 v9, s57
    v_cndmask_b32 v8, v8, v9, vcc
    v_add_u32 v7, v7, v8
    v_lshlrev_b32 v7, 7, v7
    v_and_b32 v8, 3, v1
    v_lshlrev_b32 v8, 4, v8
    v_add_u32 v7, v7, v8
    s_mov_b32 exec_lo, 0xffffff
    s_mov_b32 exec_hi, 0
    buffer_load_dwordx4 v[16:19], v7, s[8:11], s50 offen sc1
    s_waitcnt vmcnt(0)
    v_and_b32 v16, v16, v17
    v_and_b32 v18, v18, v19
    v_and_b32 v16, v16, v18
    v_cmp_eq_u32 vcc, 1, v16
    s_and_b32 s58, vcc_lo, 0xffffff
    s_cmp_eq_u32 s58, 0xffffff
    s_cbranch_scc1 pw_39_ok
    s_mov_b32 s59, 0
pw_39:
    s_sleep 32
    buffer_load_dwordx4 v[16:19], v7, s[8:11], s50 offen sc1
    s_waitcnt vmcnt(0)
    v_and_b32 v16, v16, v17
    v_and_b32 v18, v18, v19
    v_and_b32 v16, v16, v18
    v_cmp_eq_u32 vcc, 1, v16
    s_and_b32 s58, vcc_lo, 0xffffff
    s_cmp_eq_u32 s58, 0xffffff
    s_cbranch_scc1 pw_39_ok
    s_add_u32 s59, s59, 1
    s_cmp_lt_u32 s59, 50000
    s_cbranch_scc1 pw_39
pw_39_ok:
    s_mov_b64 exec, -1
    s_mov_b32 s63, s35
    s_mov_b32 s35, 0
    s_lshr_b32 s56, s35, 1
    s_mul_i32 s57, s56, 11264
    s_add_u32 s57, s57, 0
    s_lshl_b32 s56, s56, 3
    s_add_u32 s56, s56, 0
    s_bitcmp1_b32 s35, 0
    s_cbranch_scc1 sd_40_v
    s_lshl_b32 s56, s56, 11
    s_add_u32 s58, s66, 80
    s_lshl_b32 s58, s58, 15
    s_add_u32 s58, s58, s56
    s_add_u32 s58, s58, 16777216
    s_add_u32 s59, s67, 80
    s_lshl_b32 s59, s59, 15
    s_add_u32 s59, s59, s56
    s_add_u32 s59, s59, 16777216
    s_add_u32 m0, s57, 0
    s_add_u32 s56, s58, 0
    buffer_load_dwordx4 v2, s[8:11], s56 offen sc1 lds
    s_add_u32 m0, s57, 1024
    s_add_u32 s56, s58, 1024
    buffer_load_dwordx4 v2, s[8:11], s56 offen sc1 lds
    s_add_u32 m0, s57, 2048
    s_add_u32 s56, s58, 32768
    buffer_load_dwordx4 v2, s[8:11], s56 offen sc1 lds
    s_add_u32 m0, s57, 3072
    s_add_u32 s56, s58, 33792
    buffer_load_dwordx4 v2, s[8:11], s56 offen sc1 lds
    s_add_u32 m0, s57, 4096
    s_add_u32 s56, s59, 0
    buffer_load_dwordx4 v2, s[8:11], s56 offen sc1 lds
    s_add_u32 m0, s57, 5120
    s_add_u32 s56, s59, 1024
    buffer_load_dwordx4 v2, s[8:11], s56 offen sc1 lds
    s_branch sd_40_e
sd_40_v:
    s_mul_i32 s56, s56, 5120
    s_add_u32 s56, s56, s53
    s_add_u32 m0, s57, 6144
    s_add_u32 s58, s56, 0
    buffer_load_dwordx4 v2, s[8:11], s58 offen sc1 lds
    s_add_u32 m0, s57, 7168
    s_add_u32 s58, s56, 1024
    buffer_load_dwordx4 v2, s[8:11], s58 offen sc1 lds
    s_add_u32 m0, s57, 8192
    s_add_u32 s58, s56, 2048
    buffer_load_dwordx4 v2, s[8:11], s58 offen sc1 lds
    s_add_u32 m0, s57, 9216
    s_add_u32 s58, s56, 3072
    buffer_load_dwordx4 v2, s[8:11], s58 offen sc1 lds
    s_add_u32 m0, s57, 10240
    s_add_u32 s58, s56, 4096
    buffer_load_dwordx4 v2, s[8:11], s58 offen sc1 lds
sd_40_e:
    s_lshl_b32 s56, s34, 8
    s_lshl_b32 s57, s35, 6
    s_add_u32 s56, s56, s57
    s_lshl_b32 s56, s56, 4
    s_add_u32 s56, s56, 16777216
    s_lshl_b32 s57, s35, 10
    s_add_u32 s57, s57, 22528
    s_lshl_b32 s58, s66, 15
    s_add_u32 s58, s58, s56
    s_mov_b32 m0, s57
    s_add_u32 s59, s58, 32768
    buffer_load_dwordx4 v2, s[8:11], s58 offen sc1 lds
    s_add_u32 m0, s57, 4096
    s_lshl_b32 s58, s67, 15
    buffer_load_dwordx4 v2, s[8:11], s59 offen sc1 lds
    s_add_u32 s58, s58, s56
    s_add_u32 s58, s58, s68
    v_lshrrev_b32 v12, 1, v1
    v_lshlrev_b32 v12, 4, v12
    v_and_b32 v13, 1, v1
    v_lshlrev_b32 v13, 2, v13
    v_add_u32 v12, v12, v13
    s_lshl_b32 s57, s35, 9
    s_add_u32 s57, s57, 30720
    s_mov_b32 m0, s57
    s_add_u32 s59, s58, 512
    buffer_load_dword v12, s[8:11], s58 offen sc1 lds
    s_add_u32 m0, s57, 256
    s_nop 0
    buffer_load_dword v12, s[8:11], s59 offen sc1 lds
    s_mov_b32 s35, 1
    s_lshr_b32 s56, s35, 1
    s_mul_i32 s57, s56, 11264
    s_add_u32 s57, s57, 0
    s_lshl_b32 s56, s56, 3
    s_add_u32 s56, s56, 0
    s_bitcmp1_b32 s35, 0
    s_cbranch_scc1 sd_41_v
    s_lshl_b32 s56, s56, 11
    s_add_u32 s58, s66, 80
    s_lshl_b32 s58, s58, 15
    s_add_u32 s58, s58, s56
    s_add_u32 s58, s58, 16777216
    s_add_u32 s59, s67, 80
    s_lshl_b32 s59, s59, 15
    s_add_u32 s59, s59, s56
    s_add_u32 s59, s59, 16777216
    s_add_u32 m0, s57, 0
    s_add_u32 s56, s58, 0
    buffer_load_dwordx4 v2, s[8:11], s56 offen sc1 lds
    s_add_u32 m0, s57, 1024
    s_add_u32 s56, s58, 1024
    buffer_load_dwordx4 v2, s[8:11], s56 offen sc1 lds
    s_add_u32 m0, s57, 2048
    s_add_u32 s56, s58, 32768
    buffer_load_dwordx4 v2, s[8:11], s56 offen sc1 lds
    s_add_u32 m0, s57, 3072
    s_add_u32 s56, s58, 33792
    buffer_load_dwordx4 v2, s[8:11], s56 offen sc1 lds
    s_add_u32 m0, s57, 4096
    s_add_u32 s56, s59, 0
    buffer_load_dwordx4 v2, s[8:11], s56 offen sc1 lds
    s_add_u32 m0, s57, 5120
    s_add_u32 s56, s59, 1024
    buffer_load_dwordx4 v2, s[8:11], s56 offen sc1 lds
    s_branch sd_41_e
sd_41_v:
    s_mul_i32 s56, s56, 5120
    s_add_u32 s56, s56, s53
    s_add_u32 m0, s57, 6144
    s_add_u32 s58, s56, 0
    buffer_load_dwordx4 v2, s[8:11], s58 offen sc1 lds
    s_add_u32 m0, s57, 7168
    s_add_u32 s58, s56, 1024
    buffer_load_dwordx4 v2, s[8:11], s58 offen sc1 lds
    s_add_u32 m0, s57, 8192
    s_add_u32 s58, s56, 2048
    buffer_load_dwordx4 v2, s[8:11], s58 offen sc1 lds
    s_add_u32 m0, s57, 9216
    s_add_u32 s58, s56, 3072
    buffer_load_dwordx4 v2, s[8:11], s58 offen sc1 lds
    s_add_u32 m0, s57, 10240
    s_add_u32 s58, s56, 4096
    buffer_load_dwordx4 v2, s[8:11], s58 offen sc1 lds
sd_41_e:
    s_lshl_b32 s56, s34, 8
    s_lshl_b32 s57, s35, 6
    s_add_u32 s56, s56, s57
    s_lshl_b32 s56, s56, 4
    s_add_u32 s56, s56, 16777216
    s_lshl_b32 s57, s35, 10
    s_add_u32 s57, s57, 22528
    s_lshl_b32 s58, s66, 15
    s_add_u32 s58, s58, s56
    s_mov_b32 m0, s57
    s_add_u32 s59, s58, 32768
    buffer_load_dwordx4 v2, s[8:11], s58 offen sc1 lds
    s_add_u32 m0, s57, 4096
    s_lshl_b32 s58, s67, 15
    buffer_load_dwordx4 v2, s[8:11], s59 offen sc1 lds
    s_add_u32 s58, s58, s56
    s_add_u32 s58, s58, s68
    v_lshrrev_b32 v12, 1, v1
    v_lshlrev_b32 v12, 4, v12
    v_and_b32 v13, 1, v1
    v_lshlrev_b32 v13, 2, v13
    v_add_u32 v12, v12, v13
    s_lshl_b32 s57, s35, 9
    s_add_u32 s57, s57, 30720
    s_mov_b32 m0, s57
    s_add_u32 s59, s58, 512
    buffer_load_dword v12, s[8:11], s58 offen sc1 lds
    s_add_u32 m0, s57, 256
    s_nop 0
    buffer_load_dword v12, s[8:11], s59 offen sc1 lds
    s_mov_b32 s35, 2
    s_lshr_b32 s56, s35, 1
    s_mul_i32 s57, s56, 11264
    s_add_u32 s57, s57, 0
    s_lshl_b32 s56, s56, 3
    s_add_u32 s56, s56, 0
    s_bitcmp1_b32 s35, 0
    s_cbranch_scc1 sd_42_v
    s_lshl_b32 s56, s56, 11
    s_add_u32 s58, s66, 80
    s_lshl_b32 s58, s58, 15
    s_add_u32 s58, s58, s56
    s_add_u32 s58, s58, 16777216
    s_add_u32 s59, s67, 80
    s_lshl_b32 s59, s59, 15
    s_add_u32 s59, s59, s56
    s_add_u32 s59, s59, 16777216
    s_add_u32 m0, s57, 0
    s_add_u32 s56, s58, 0
    buffer_load_dwordx4 v2, s[8:11], s56 offen sc1 lds
    s_add_u32 m0, s57, 1024
    s_add_u32 s56, s58, 1024
    buffer_load_dwordx4 v2, s[8:11], s56 offen sc1 lds
    s_add_u32 m0, s57, 2048
    s_add_u32 s56, s58, 32768
    buffer_load_dwordx4 v2, s[8:11], s56 offen sc1 lds
    s_add_u32 m0, s57, 3072
    s_add_u32 s56, s58, 33792
    buffer_load_dwordx4 v2, s[8:11], s56 offen sc1 lds
    s_add_u32 m0, s57, 4096
    s_add_u32 s56, s59, 0
    buffer_load_dwordx4 v2, s[8:11], s56 offen sc1 lds
    s_add_u32 m0, s57, 5120
    s_add_u32 s56, s59, 1024
    buffer_load_dwordx4 v2, s[8:11], s56 offen sc1 lds
    s_branch sd_42_e
sd_42_v:
    s_mul_i32 s56, s56, 5120
    s_add_u32 s56, s56, s53
    s_add_u32 m0, s57, 6144
    s_add_u32 s58, s56, 0
    buffer_load_dwordx4 v2, s[8:11], s58 offen sc1 lds
    s_add_u32 m0, s57, 7168
    s_add_u32 s58, s56, 1024
    buffer_load_dwordx4 v2, s[8:11], s58 offen sc1 lds
    s_add_u32 m0, s57, 8192
    s_add_u32 s58, s56, 2048
    buffer_load_dwordx4 v2, s[8:11], s58 offen sc1 lds
    s_add_u32 m0, s57, 9216
    s_add_u32 s58, s56, 3072
    buffer_load_dwordx4 v2, s[8:11], s58 offen sc1 lds
    s_add_u32 m0, s57, 10240
    s_add_u32 s58, s56, 4096
    buffer_load_dwordx4 v2, s[8:11], s58 offen sc1 lds
sd_42_e:
    s_lshl_b32 s56, s34, 8
    s_lshl_b32 s57, s35, 6
    s_add_u32 s56, s56, s57
    s_lshl_b32 s56, s56, 4
    s_add_u32 s56, s56, 16777216
    s_lshl_b32 s57, s35, 10
    s_add_u32 s57, s57, 22528
    s_lshl_b32 s58, s66, 15
    s_add_u32 s58, s58, s56
    s_mov_b32 m0, s57
    s_add_u32 s59, s58, 32768
    buffer_load_dwordx4 v2, s[8:11], s58 offen sc1 lds
    s_add_u32 m0, s57, 4096
    s_lshl_b32 s58, s67, 15
    buffer_load_dwordx4 v2, s[8:11], s59 offen sc1 lds
    s_add_u32 s58, s58, s56
    s_add_u32 s58, s58, s68
    v_lshrrev_b32 v12, 1, v1
    v_lshlrev_b32 v12, 4, v12
    v_and_b32 v13, 1, v1
    v_lshlrev_b32 v13, 2, v13
    v_add_u32 v12, v12, v13
    s_lshl_b32 s57, s35, 9
    s_add_u32 s57, s57, 30720
    s_mov_b32 m0, s57
    s_add_u32 s59, s58, 512
    buffer_load_dword v12, s[8:11], s58 offen sc1 lds
    s_add_u32 m0, s57, 256
    s_nop 0
    buffer_load_dword v12, s[8:11], s59 offen sc1 lds
    s_mov_b32 s35, 3
    s_lshr_b32 s56, s35, 1
    s_mul_i32 s57, s56, 11264
    s_add_u32 s57, s57, 0
    s_lshl_b32 s56, s56, 3
    s_add_u32 s56, s56, 0
    s_bitcmp1_b32 s35, 0
    s_cbranch_scc1 sd_43_v
    s_lshl_b32 s56, s56, 11
    s_add_u32 s58, s66, 80
    s_lshl_b32 s58, s58, 15
    s_add_u32 s58, s58, s56
    s_add_u32 s58, s58, 16777216
    s_add_u32 s59, s67, 80
    s_lshl_b32 s59, s59, 15
    s_add_u32 s59, s59, s56
    s_add_u32 s59, s59, 16777216
    s_add_u32 m0, s57, 0
    s_add_u32 s56, s58, 0
    buffer_load_dwordx4 v2, s[8:11], s56 offen sc1 lds
    s_add_u32 m0, s57, 1024
    s_add_u32 s56, s58, 1024
    buffer_load_dwordx4 v2, s[8:11], s56 offen sc1 lds
    s_add_u32 m0, s57, 2048
    s_add_u32 s56, s58, 32768
    buffer_load_dwordx4 v2, s[8:11], s56 offen sc1 lds
    s_add_u32 m0, s57, 3072
    s_add_u32 s56, s58, 33792
    buffer_load_dwordx4 v2, s[8:11], s56 offen sc1 lds
    s_add_u32 m0, s57, 4096
    s_add_u32 s56, s59, 0
    buffer_load_dwordx4 v2, s[8:11], s56 offen sc1 lds
    s_add_u32 m0, s57, 5120
    s_add_u32 s56, s59, 1024
    buffer_load_dwordx4 v2, s[8:11], s56 offen sc1 lds
    s_branch sd_43_e
sd_43_v:
    s_mul_i32 s56, s56, 5120
    s_add_u32 s56, s56, s53
    s_add_u32 m0, s57, 6144
    s_add_u32 s58, s56, 0
    buffer_load_dwordx4 v2, s[8:11], s58 offen sc1 lds
    s_add_u32 m0, s57, 7168
    s_add_u32 s58, s56, 1024
    buffer_load_dwordx4 v2, s[8:11], s58 offen sc1 lds
    s_add_u32 m0, s57, 8192
    s_add_u32 s58, s56, 2048
    buffer_load_dwordx4 v2, s[8:11], s58 offen sc1 lds
    s_add_u32 m0, s57, 9216
    s_add_u32 s58, s56, 3072
    buffer_load_dwordx4 v2, s[8:11], s58 offen sc1 lds
    s_add_u32 m0, s57, 10240
    s_add_u32 s58, s56, 4096
    buffer_load_dwordx4 v2, s[8:11], s58 offen sc1 lds
sd_43_e:
    s_lshl_b32 s56, s34, 8
    s_lshl_b32 s57, s35, 6
    s_add_u32 s56, s56, s57
    s_lshl_b32 s56, s56, 4
    s_add_u32 s56, s56, 16777216
    s_lshl_b32 s57, s35, 10
    s_add_u32 s57, s57, 22528
    s_lshl_b32 s58, s66, 15
    s_add_u32 s58, s58, s56
    s_mov_b32 m0, s57
    s_add_u32 s59, s58, 32768
    buffer_load_dwordx4 v2, s[8:11], s58 offen sc1 lds
    s_add_u32 m0, s57, 4096
    s_lshl_b32 s58, s67, 15
    buffer_load_dwordx4 v2, s[8:11], s59 offen sc1 lds
    s_add_u32 s58, s58, s56
    s_add_u32 s58, s58, s68
    v_lshrrev_b32 v12, 1, v1
    v_lshlrev_b32 v12, 4, v12
    v_and_b32 v13, 1, v1
    v_lshlrev_b32 v13, 2, v13
    v_add_u32 v12, v12, v13
    s_lshl_b32 s57, s35, 9
    s_add_u32 s57, s57, 30720
    s_mov_b32 m0, s57
    s_add_u32 s59, s58, 512
    buffer_load_dword v12, s[8:11], s58 offen sc1 lds
    s_add_u32 m0, s57, 256
    s_nop 0
    buffer_load_dword v12, s[8:11], s59 offen sc1 lds
    s_mov_b32 s35, s63
    s_waitcnt vmcnt(0)
concat_heads__linear_kernel_hedgehog__mha_block__prompt_kernel_prep_w:
    s_mul_i32 s55, s32, 3
    s_add_u32 s55, s55, 0
    s_min_u32 s55, s55, 21
    s_cmp_ge_u32 s55, 11
    s_cselect_b32 s56, 1, 0
    s_mul_i32 s57, s56, 11
    s_sub_u32 s55, s55, s57
    s_mul_i32 s57, s56, 11264
    s_lshl_b32 s58, s55, 10
    s_add_u32 s50, s57, s58
    s_lshl_b32 s56, s56, 3
    s_cmp_ge_u32 s55, 6
    s_cbranch_scc1 kd_44_v
    s_lshr_b32 s57, s55, 1
    s_add_u32 s58, s66, s57
    s_cmp_eq_u32 s57, 2
    s_cselect_b32 s58, s67, s58
    s_add_u32 s58, s58, 80
    s_lshl_b32 s58, s58, 15
    s_lshl_b32 s56, s56, 11
    s_add_u32 s58, s58, s56
    s_and_b32 s57, s55, 1
    s_lshl_b32 s57, s57, 10
    s_add_u32 s58, s58, s57
    s_add_u32 s44, s58, 16777216
    s_mov_b32 s47, 2048
    s_branch kd_44_e
kd_44_v:
    s_mul_i32 s56, s56, 5120
    s_sub_u32 s57, s55, 6
    s_lshl_b32 s57, s57, 10
    s_add_u32 s56, s56, s57
    s_add_u32 s44, s56, s53
    s_mov_b32 s47, 5120
kd_44_e:
    s_add_u32 s44, s44, s47
    s_mul_i32 s55, s32, 3
    s_add_u32 s55, s55, 1
    s_min_u32 s55, s55, 21
    s_cmp_ge_u32 s55, 11
    s_cselect_b32 s56, 1, 0
    s_mul_i32 s57, s56, 11
    s_sub_u32 s55, s55, s57
    s_mul_i32 s57, s56, 11264
    s_lshl_b32 s58, s55, 10
    s_add_u32 s51, s57, s58
    s_lshl_b32 s56, s56, 3
    s_cmp_ge_u32 s55, 6
    s_cbranch_scc1 kd_45_v
    s_lshr_b32 s57, s55, 1
    s_add_u32 s58, s66, s57
    s_cmp_eq_u32 s57, 2
    s_cselect_b32 s58, s67, s58
    s_add_u32 s58, s58, 80
    s_lshl_b32 s58, s58, 15
    s_lshl_b32 s56, s56, 11
    s_add_u32 s58, s58, s56
    s_and_b32 s57, s55, 1
    s_lshl_b32 s57, s57, 10
    s_add_u32 s58, s58, s57
    s_add_u32 s45, s58, 16777216
    s_mov_b32 s48, 2048
    s_branch kd_45_e
kd_45_v:
    s_mul_i32 s56, s56, 5120
    s_sub_u32 s57, s55, 6
    s_lshl_b32 s57, s57, 10
    s_add_u32 s56, s56, s57
    s_add_u32 s45, s56, s53
    s_mov_b32 s48, 5120
kd_45_e:
    s_add_u32 s45, s45, s48
    s_mul_i32 s55, s32, 3
    s_add_u32 s55, s55, 2
    s_min_u32 s55, s55, 21
    s_cmp_ge_u32 s55, 11
    s_cselect_b32 s56, 1, 0
    s_mul_i32 s57, s56, 11
    s_sub_u32 s55, s55, s57
    s_mul_i32 s57, s56, 11264
    s_lshl_b32 s58, s55, 10
    s_add_u32 s52, s57, s58
    s_lshl_b32 s56, s56, 3
    s_cmp_ge_u32 s55, 6
    s_cbranch_scc1 kd_46_v
    s_lshr_b32 s57, s55, 1
    s_add_u32 s58, s66, s57
    s_cmp_eq_u32 s57, 2
    s_cselect_b32 s58, s67, s58
    s_add_u32 s58, s58, 80
    s_lshl_b32 s58, s58, 15
    s_lshl_b32 s56, s56, 11
    s_add_u32 s58, s58, s56
    s_and_b32 s57, s55, 1
    s_lshl_b32 s57, s57, 10
    s_add_u32 s58, s58, s57
    s_add_u32 s46, s58, 16777216
    s_mov_b32 s49, 2048
    s_branch kd_46_e
kd_46_v:
    s_mul_i32 s56, s56, 5120
    s_sub_u32 s57, s55, 6
    s_lshl_b32 s57, s57, 10
    s_add_u32 s56, s56, s57
    s_add_u32 s46, s56, s53
    s_mov_b32 s49, 5120
kd_46_e:
    s_add_u32 s46, s46, s49
    s_barrier
    s_branch concat_heads__linear_kernel_hedgehog__mha_block__prompt_kernel_p2entry
concat_heads__linear_kernel_hedgehog__mha_block__prompt_kernel_loader:
    v_lshrrev_b32 v7, 2, v1
    s_lshl_b32 s44, s35, 5
    v_add_u32 v7, s44, v7
    v_mul_u32_u24 v7, 1280, v7
    v_lshrrev_b32 v8, 4, v1
    v_and_b32 v9, 3, v1
    v_xor_b32 v10, v9, v8
    v_and_b32 v10, 3, v10
    v_lshlrev_b32 v10, 4, v10
    v_add_u32 v192, v7, v10
    v_add_u32 v193, 20480, v192
    s_lshl_b32 s44, s35, 3
    v_add_u32 v7, s44, v8
    v_mul_u32_u24 v7, 3840, v7
    v_lshrrev_b32 v10, 2, v1
    v_xor_b32 v10, v10, v8
    v_and_b32 v10, 3, v10
    v_lshlrev_b32 v10, 6, v10
    v_lshlrev_b32 v9, 4, v9
    v_add3_u32 v194, v7, v10, v9
    s_lshl_b32 s44, s35, 11
    s_add_u32 s44, s44, 32768
    s_add_u32 s45, s44, 8192
    s_and_b32 s52, s37, 3
    s_mul_i32 s52, s52, 6
    s_lshl_b32 s54, s38, 1
    s_add_u32 s52, s52, s54
    s_lshl_b32 s54, s65, 2
    s_add_u32 s52, s52, s54
    s_cmp_ge_u32 s52, 40
    s_cselect_b32 s54, 40, 0
    s_sub_u32 s52, s52, s54
    s_cmp_ge_u32 s52, 20
    s_cselect_b32 s54, 20, 0
    s_sub_u32 s52, s52, s54
    s_mov_b32 s56, s52
    s_mul_i32 s46, s37, 163840
    s_lshl_b32 s54, s52, 6
    s_add_u32 s46, s46, s54
    s_lshl_b32 s47, s38, 8
    s_mul_i32 s54, s52, 122880
    s_add_u32 s47, s47, s54
    s_mov_b32 s48, 0
    s_mov_b32 s49, 0
    s_mov_b32 s12, s24
    s_and_b32 s13, s25, 0xffff
    s_mov_b32 s14, 0x280000
    s_mov_b32 s15, 0x20000
    s_mov_b32 s16, s26
    s_and_b32 s17, s27, 0xffff
    s_mov_b32 s18, 0x258000
    s_mov_b32 s19, 0x20000
    s_add_u32 s50, s48, s44
    s_add_u32 m0, s50, 0
    s_add_u32 s51, s47, 0
    buffer_load_dwordx4 v192, s[12:15], s46 offen lds
    s_add_u32 s50, s48, s45
    s_add_u32 m0, s50, 0
    s_nop 0
    buffer_load_dwordx4 v194, s[16:19], s51 offen lds
    s_add_u32 s50, s48, s44
    s_add_u32 m0, s50, 1024
    s_add_u32 s51, s47, 15360
    buffer_load_dwordx4 v193, s[12:15], s46 offen lds
    s_add_u32 s50, s48, s45
    s_add_u32 m0, s50, 1024
    s_nop 0
    buffer_load_dwordx4 v194, s[16:19], s51 offen lds
    s_add_u32 s46, s46, 64
    s_add_u32 s47, s47, 122880
    s_add_u32 s48, s48, 16384
    s_and_b32 s48, s48, 0x1ffff
    s_add_u32 s56, s56, 1
    s_cmp_eq_u32 s56, 20
    s_cselect_b32 s54, 1280, 0
    s_sub_u32 s46, s46, s54
    s_cmp_eq_u32 s56, 20
    s_cselect_b32 s54, 2457600, 0
    s_sub_u32 s47, s47, s54
    s_cmp_eq_u32 s56, 20
    s_cselect_b32 s56, 0, s56
    s_add_u32 s49, s49, 1
    s_cmp_eq_u32 s49, 20
    s_cbranch_scc0 concat_heads__linear_kernel_hedgehog__mha_block__prompt_kernel_lk_p0
    s_mov_b32 s12, s20
    s_and_b32 s13, s21, 0xffff
    s_mov_b32 s14, 0x280000
    s_mov_b32 s15, 0x20000
    s_mov_b32 s16, s22
    s_and_b32 s17, s23, 0xffff
    s_mov_b32 s18, 0x258000
    s_mov_b32 s19, 0x20000
concat_heads__linear_kernel_hedgehog__mha_block__prompt_kernel_lk_p0:
    s_add_u32 s50, s48, s44
    s_add_u32 m0, s50, 0
    s_add_u32 s51, s47, 0
    buffer_load_dwordx4 v192, s[12:15], s46 offen lds
    s_add_u32 s50, s48, s45
    s_add_u32 m0, s50, 0
    s_nop 0
    buffer_load_dwordx4 v194, s[16:19], s51 offen lds
    s_add_u32 s50, s48, s44
    s_add_u32 m0, s50, 1024
    s_add_u32 s51, s47, 15360
    buffer_load_dwordx4 v193, s[12:15], s46 offen lds
    s_add_u32 s50, s48, s45
    s_add_u32 m0, s50, 1024
    s_nop 0
    buffer_load_dwordx4 v194, s[16:19], s51 offen lds
    s_add_u32 s46, s46, 64
    s_add_u32 s47, s47, 122880
    s_add_u32 s48, s48, 16384
    s_and_b32 s48, s48, 0x1ffff
    s_add_u32 s56, s56, 1
    s_cmp_eq_u32 s56, 20
    s_cselect_b32 s54, 1280, 0
    s_sub_u32 s46, s46, s54
    s_cmp_eq_u32 s56, 20
    s_cselect_b32 s54, 2457600, 0
    s_sub_u32 s47, s47, s54
    s_cmp_eq_u32 s56, 20
    s_cselect_b32 s56, 0, s56
    s_add_u32 s49, s49, 1
    s_cmp_eq_u32 s49, 20
    s_cbranch_scc0 concat_heads__linear_kernel_hedgehog__mha_block__prompt_kernel_lk_p1
    s_mov_b32 s12, s20
    s_and_b32 s13, s21, 0xffff
    s_mov_b32 s14, 0x280000
    s_mov_b32 s15, 0x20000
    s_mov_b32 s16, s22
    s_and_b32 s17, s23, 0xffff
    s_mov_b32 s18, 0x258000
    s_mov_b32 s19, 0x20000
concat_heads__linear_kernel_hedgehog__mha_block__prompt_kernel_lk_p1:
    s_add_u32 s50, s48, s44
    s_add_u32 m0, s50, 0
    s_add_u32 s51, s47, 0
    buffer_load_dwordx4 v192, s[12:15], s46 offen lds
    s_add_u32 s50, s48, s45
    s_add_u32 m0, s50, 0
    s_nop 0
    buffer_load_dwordx4 v194, s[16:19], s51 offen lds
    s_add_u32 s50, s48, s44
    s_add_u32 m0, s50, 1024
    s_add_u32 s51, s47, 15360
    buffer_load_dwordx4 v193, s[12:15], s46 offen lds
    s_add_u32 s50, s48, s45
    s_add_u32 m0, s50, 1024
    s_nop 0
    buffer_load_dwordx4 v194, s[16:19], s51 offen lds
    s_add_u32 s46, s46, 64
    s_add_u32 s47, s47, 122880
    s_add_u32 s48, s48, 16384
    s_and_b32 s48, s48, 0x1ffff
    s_add_u32 s56, s56, 1
    s_cmp_eq_u32 s56, 20
    s_cselect_b32 s54, 1280, 0
    s_sub_u32 s46, s46, s54
    s_cmp_eq_u32 s56, 20
    s_cselect_b32 s54, 2457600, 0
    s_sub_u32 s47, s47, s54
    s_cmp_eq_u32 s56, 20
    s_cselect_b32 s56, 0, s56
    s_add_u32 s49, s49, 1
    s_cmp_eq_u32 s49, 20
    s_cbranch_scc0 concat_heads__linear_kernel_hedgehog__mha_block__prompt_kernel_lk_p2
    s_mov_b32 s12, s20
    s_and_b32 s13, s21, 0xffff
    s_mov_b32 s14, 0x280000
    s_mov_b32 s15, 0x20000
    s_mov_b32 s16, s22
    s_and_b32 s17, s23, 0xffff
    s_mov_b32 s18, 0x258000
    s_mov_b32 s19, 0x20000
concat_heads__linear_kernel_hedgehog__mha_block__prompt_kernel_lk_p2:
    s_add_u32 s50, s48, s44
    s_add_u32 m0, s50, 0
    s_add_u32 s51, s47, 0
    buffer_load_dwordx4 v192, s[12:15], s46 offen lds
    s_add_u32 s50, s48, s45
    s_add_u32 m0, s50, 0
    s_nop 0
    buffer_load_dwordx4 v194, s[16:19], s51 offen lds
    s_add_u32 s50, s48, s44
    s_add_u32 m0, s50, 1024
    s_add_u32 s51, s47, 15360
    buffer_load_dwordx4 v193, s[12:15], s46 offen lds
    s_add_u32 s50, s48, s45
    s_add_u32 m0, s50, 1024
    s_nop 0
    buffer_load_dwordx4 v194, s[16:19], s51 offen lds
    s_add_u32 s46, s46, 64
    s_add_u32 s47, s47, 122880
    s_add_u32 s48, s48, 16384
    s_and_b32 s48, s48, 0x1ffff
    s_add_u32 s56, s56, 1
    s_cmp_eq_u32 s56, 20
    s_cselect_b32 s54, 1280, 0
    s_sub_u32 s46, s46, s54
    s_cmp_eq_u32 s56, 20
    s_cselect_b32 s54, 2457600, 0
    s_sub_u32 s47, s47, s54
    s_cmp_eq_u32 s56, 20
    s_cselect_b32 s56, 0, s56
    s_add_u32 s49, s49, 1
    s_cmp_eq_u32 s49, 20
    s_cbranch_scc0 concat_heads__linear_kernel_hedgehog__mha_block__prompt_kernel_lk_p3
    s_mov_b32 s12, s20
    s_and_b32 s13, s21, 0xffff
    s_mov_b32 s14, 0x280000
    s_mov_b32 s15, 0x20000
    s_mov_b32 s16, s22
    s_and_b32 s17, s23, 0xffff
    s_mov_b32 s18, 0x258000
    s_mov_b32 s19, 0x20000
concat_heads__linear_kernel_hedgehog__mha_block__prompt_kernel_lk_p3:
    s_add_u32 s50, s48, s44
    s_add_u32 m0, s50, 0
    s_add_u32 s51, s47, 0
    buffer_load_dwordx4 v192, s[12:15], s46 offen lds
    s_add_u32 s50, s48, s45
    s_add_u32 m0, s50, 0
    s_nop 0
    buffer_load_dwordx4 v194, s[16:19], s51 offen lds
    s_add_u32 s50, s48, s44
    s_add_u32 m0, s50, 1024
    s_add_u32 s51, s47, 15360
    buffer_load_dwordx4 v193, s[12:15], s46 offen lds
    s_add_u32 s50, s48, s45
    s_add_u32 m0, s50, 1024
    s_nop 0
    buffer_load_dwordx4 v194, s[16:19], s51 offen lds
    s_add_u32 s46, s46, 64
    s_add_u32 s47, s47, 122880
    s_add_u32 s48, s48, 16384
    s_and_b32 s48, s48, 0x1ffff
    s_add_u32 s56, s56, 1
    s_cmp_eq_u32 s56, 20
    s_cselect_b32 s54, 1280, 0
    s_sub_u32 s46, s46, s54
    s_cmp_eq_u32 s56, 20
    s_cselect_b32 s54, 2457600, 0
    s_sub_u32 s47, s47, s54
    s_cmp_eq_u32 s56, 20
    s_cselect_b32 s56, 0, s56
    s_add_u32 s49, s49, 1
    s_cmp_eq_u32 s49, 20
    s_cbranch_scc0 concat_heads__linear_kernel_hedgehog__mha_block__prompt_kernel_lk_p4
    s_mov_b32 s12, s20
    s_and_b32 s13, s21, 0xffff
    s_mov_b32 s14, 0x280000
    s_mov_b32 s15, 0x20000
    s_mov_b32 s16, s22
    s_and_b32 s17, s23, 0xffff
    s_mov_b32 s18, 0x258000
    s_mov_b32 s19, 0x20000
concat_heads__linear_kernel_hedgehog__mha_block__prompt_kernel_lk_p4:
    s_add_u32 s50, s48, s44
    s_add_u32 m0, s50, 0
    s_add_u32 s51, s47, 0
    buffer_load_dwordx4 v192, s[12:15], s46 offen lds
    s_add_u32 s50, s48, s45
    s_add_u32 m0, s50, 0
    s_nop 0
    buffer_load_dwordx4 v194, s[16:19], s51 offen lds
    s_add_u32 s50, s48, s44
    s_add_u32 m0, s50, 1024
    s_add_u32 s51, s47, 15360
    buffer_load_dwordx4 v193, s[12:15], s46 offen lds
    s_add_u32 s50, s48, s45
    s_add_u32 m0, s50, 1024
    s_nop 0
    buffer_load_dwordx4 v194, s[16:19], s51 offen lds
    s_add_u32 s46, s46, 64
    s_add_u32 s47, s47, 122880
    s_add_u32 s48, s48, 16384
    s_and_b32 s48, s48, 0x1ffff
    s_add_u32 s56, s56, 1
    s_cmp_eq_u32 s56, 20
    s_cselect_b32 s54, 1280, 0
    s_sub_u32 s46, s46, s54
    s_cmp_eq_u32 s56, 20
    s_cselect_b32 s54, 2457600, 0
    s_sub_u32 s47, s47, s54
    s_cmp_eq_u32 s56, 20
    s_cselect_b32 s56, 0, s56
    s_add_u32 s49, s49, 1
    s_cmp_eq_u32 s49, 20
    s_cbranch_scc0 concat_heads__linear_kernel_hedgehog__mha_block__prompt_kernel_lk_p5
    s_mov_b32 s12, s20
    s_and_b32 s13, s21, 0xffff
    s_mov_b32 s14, 0x280000
    s_mov_b32 s15, 0x20000
    s_mov_b32 s16, s22
    s_and_b32 s17, s23, 0xffff
    s_mov_b32 s18, 0x258000
    s_mov_b32 s19, 0x20000
concat_heads__linear_kernel_hedgehog__mha_block__prompt_kernel_lk_p5:
    s_add_u32 s50, s48, s44
    s_add_u32 m0, s50, 0
    s_add_u32 s51, s47, 0
    buffer_load_dwordx4 v192, s[12:15], s46 offen lds
    s_add_u32 s50, s48, s45
    s_add_u32 m0, s50, 0
    s_nop 0
    buffer_load_dwordx4 v194, s[16:19], s51 offen lds
    s_add_u32 s50, s48, s44
    s_add_u32 m0, s50, 1024
    s_add_u32 s51, s47, 15360
    buffer_load_dwordx4 v193, s[12:15], s46 offen lds
    s_add_u32 s50, s48, s45
    s_add_u32 m0, s50, 1024
    s_nop 0
    buffer_load_dwordx4 v194, s[16:19], s51 offen lds
    s_add_u32 s46, s46, 64
    s_add_u32 s47, s47, 122880
    s_add_u32 s48, s48, 16384
    s_and_b32 s48, s48, 0x1ffff
    s_add_u32 s56, s56, 1
    s_cmp_eq_u32 s56, 20
    s_cselect_b32 s54, 1280, 0
    s_sub_u32 s46, s46, s54
    s_cmp_eq_u32 s56, 20
    s_cselect_b32 s54, 2457600, 0
    s_sub_u32 s47, s47, s54
    s_cmp_eq_u32 s56, 20
    s_cselect_b32 s56, 0, s56
    s_add_u32 s49, s49, 1
    s_cmp_eq_u32 s49, 20
    s_cbranch_scc0 concat_heads__linear_kernel_hedgehog__mha_block__prompt_kernel_lk_p6
    s_mov_b32 s12, s20
    s_and_b32 s13, s21, 0xffff
    s_mov_b32 s14, 0x280000
    s_mov_b32 s15, 0x20000
    s_mov_b32 s16, s22
    s_and_b32 s17, s23, 0xffff
    s_mov_b32 s18, 0x258000
    s_mov_b32 s19, 0x20000
concat_heads__linear_kernel_hedgehog__mha_block__prompt_kernel_lk_p6:
    s_waitcnt vmcnt(24)
    s_barrier
    s_mov_b32 s52, 0
concat_heads__linear_kernel_hedgehog__mha_block__prompt_kernel_lkloop:
    s_waitcnt vmcnt(20)
    s_barrier
    s_add_u32 s50, s48, s44
    s_add_u32 m0, s50, 0
    s_add_u32 s51, s47, 0
    buffer_load_dwordx4 v192, s[12:15], s46 offen lds
    s_add_u32 s50, s48, s45
    s_add_u32 m0, s50, 0
    s_nop 0
    buffer_load_dwordx4 v194, s[16:19], s51 offen lds
    s_add_u32 s50, s48, s44
    s_add_u32 m0, s50, 1024
    s_add_u32 s51, s47, 15360
    buffer_load_dwordx4 v193, s[12:15], s46 offen lds
    s_add_u32 s50, s48, s45
    s_add_u32 m0, s50, 1024
    s_nop 0
    buffer_load_dwordx4 v194, s[16:19], s51 offen lds
    s_add_u32 s46, s46, 64
    s_add_u32 s47, s47, 122880
    s_add_u32 s48, s48, 16384
    s_and_b32 s48, s48, 0x1ffff
    s_add_u32 s56, s56, 1
    s_cmp_eq_u32 s56, 20
    s_cselect_b32 s54, 1280, 0
    s_sub_u32 s46, s46, s54
    s_cmp_eq_u32 s56, 20
    s_cselect_b32 s54, 2457600, 0
    s_sub_u32 s47, s47, s54
    s_cmp_eq_u32 s56, 20
    s_cselect_b32 s56, 0, s56
    s_add_u32 s49, s49, 1
    s_cmp_eq_u32 s49, 20
    s_cbranch_scc0 concat_heads__linear_kernel_hedgehog__mha_block__prompt_kernel_lk_lp
    s_mov_b32 s12, s20
    s_and_b32 s13, s21, 0xffff
    s_mov_b32 s14, 0x280000
    s_mov_b32 s15, 0x20000
    s_mov_b32 s16, s22
    s_and_b32 s17, s23, 0xffff
    s_mov_b32 s18, 0x258000
    s_mov_b32 s19, 0x20000
concat_heads__linear_kernel_hedgehog__mha_block__prompt_kernel_lk_lp:
    s_add_u32 s52, s52, 1
    s_cmp_lt_u32 s52, 33
    s_cbranch_scc1 concat_heads__linear_kernel_hedgehog__mha_block__prompt_kernel_lkloop
    s_mov_b32 s54, 13778944
    s_mul_i32 s56, s33, 20
    s_add_u32 s57, s56, 19
    s_lshr_b32 s56, s56, 7
    s_lshr_b32 s57, s57, 7
    v_lshrrev_b32 v7, 3, v1
    v_min_u32 v7, 2, v7
    v_mul_u32_u24 v7, 5, v7
    v_bfe_u32 v8, v1, 2, 1
    v_cmp_eq_u32 vcc, 1, v8
    v_mov_b32 v8, s56
    v_mov_b32 v9, s57
    v_cndmask_b32 v8, v8, v9, vcc
    v_add_u32 v7, v7, v8
    v_lshlrev_b32 v7, 7, v7
    v_and_b32 v8, 3, v1
    v_lshlrev_b32 v8, 4, v8
    v_add_u32 v7, v7, v8
    s_waitcnt vmcnt(20)
    s_barrier
    s_waitcnt vmcnt(16)
    s_barrier
    s_waitcnt vmcnt(12)
    s_barrier
    s_mov_b32 exec_lo, 0xffffff
    s_mov_b32 exec_hi, 0
    buffer_load_dwordx4 v[16:19], v7, s[8:11], s54 offen sc1
    s_mov_b64 exec, -1
    s_waitcnt vmcnt(8)
    s_barrier
    s_waitcnt vmcnt(0)
    s_barrier
    s_mov_b32 s63, 0
    v_and_b32 v16, v16, v17
    v_and_b32 v18, v18, v19
    v_and_b32 v16, v16, v18
    v_cmp_eq_u32 vcc, 1, v16
    s_and_b32 s58, vcc_lo, 0xffffff
    s_cmp_eq_u32 s58, 0xffffff
    s_cbranch_scc0 ea_47
    s_mov_b32 s63, 1
    s_lshr_b32 s56, s35, 1
    s_mul_i32 s57, s56, 11264
    s_add_u32 s57, s57, 0
    s_lshl_b32 s56, s56, 3
    s_add_u32 s56, s56, 0
    s_bitcmp1_b32 s35, 0
    s_cbranch_scc1 sd_48_v
    s_lshl_b32 s56, s56, 11
    s_add_u32 s58, s66, 80
    s_lshl_b32 s58, s58, 15
    s_add_u32 s58, s58, s56
    s_add_u32 s58, s58, 16777216
    s_add_u32 s59, s67, 80
    s_lshl_b32 s59, s59, 15
    s_add_u32 s59, s59, s56
    s_add_u32 s59, s59, 16777216
    s_add_u32 m0, s57, 0
    s_add_u32 s56, s58, 0
    buffer_load_dwordx4 v2, s[8:11], s56 offen sc1 lds
    s_add_u32 m0, s57, 1024
    s_add_u32 s56, s58, 1024
    buffer_load_dwordx4 v2, s[8:11], s56 offen sc1 lds
    s_add_u32 m0, s57, 2048
    s_add_u32 s56, s58, 32768
    buffer_load_dwordx4 v2, s[8:11], s56 offen sc1 lds
    s_add_u32 m0, s57, 3072
    s_add_u32 s56, s58, 33792
    buffer_load_dwordx4 v2, s[8:11], s56 offen sc1 lds
    s_add_u32 m0, s57, 4096
    s_add_u32 s56, s59, 0
    buffer_load_dwordx4 v2, s[8:11], s56 offen sc1 lds
    s_add_u32 m0, s57, 5120
    s_add_u32 s56, s59, 1024
    buffer_load_dwordx4 v2, s[8:11], s56 offen sc1 lds
    s_branch sd_48_e
sd_48_v:
    s_mul_i32 s56, s56, 5120
    s_add_u32 s56, s56, s53
    s_add_u32 m0, s57, 6144
    s_add_u32 s58, s56, 0
    buffer_load_dwordx4 v2, s[8:11], s58 offen sc1 lds
    s_add_u32 m0, s57, 7168
    s_add_u32 s58, s56, 1024
    buffer_load_dwordx4 v2, s[8:11], s58 offen sc1 lds
    s_add_u32 m0, s57, 8192
    s_add_u32 s58, s56, 2048
    buffer_load_dwordx4 v2, s[8:11], s58 offen sc1 lds
    s_add_u32 m0, s57, 9216
    s_add_u32 s58, s56, 3072
    buffer_load_dwordx4 v2, s[8:11], s58 offen sc1 lds
    s_add_u32 m0, s57, 10240
    s_add_u32 s58, s56, 4096
    buffer_load_dwordx4 v2, s[8:11], s58 offen sc1 lds
sd_48_e:
    s_lshl_b32 s56, s34, 8
    s_lshl_b32 s57, s35, 6
    s_add_u32 s56, s56, s57
    s_lshl_b32 s56, s56, 4
    s_add_u32 s56, s56, 16777216
    s_lshl_b32 s57, s35, 10
    s_add_u32 s57, s57, 22528
    s_lshl_b32 s58, s66, 15
    s_add_u32 s58, s58, s56
    s_mov_b32 m0, s57
    s_add_u32 s59, s58, 32768
    buffer_load_dwordx4 v2, s[8:11], s58 offen sc1 lds
    s_add_u32 m0, s57, 4096
    s_lshl_b32 s58, s67, 15
    buffer_load_dwordx4 v2, s[8:11], s59 offen sc1 lds
    s_add_u32 s58, s58, s56
    s_add_u32 s58, s58, s68
    v_lshrrev_b32 v12, 1, v1
    v_lshlrev_b32 v12, 4, v12
    v_and_b32 v13, 1, v1
    v_lshlrev_b32 v13, 2, v13
    v_add_u32 v12, v12, v13
    s_lshl_b32 s57, s35, 9
    s_add_u32 s57, s57, 30720
    s_mov_b32 m0, s57
    s_add_u32 s59, s58, 512
    buffer_load_dword v12, s[8:11], s58 offen sc1 lds
    s_add_u32 m0, s57, 256
    s_nop 0
    buffer_load_dword v12, s[8:11], s59 offen sc1 lds
ea_47:
    s_mul_i32 s55, s32, 3
    s_add_u32 s55, s55, 0
    s_min_u32 s55, s55, 21
    s_cmp_ge_u32 s55, 11
    s_cselect_b32 s56, 1, 0
    s_mul_i32 s57, s56, 11
    s_sub_u32 s55, s55, s57
    s_mul_i32 s57, s56, 11264
    s_lshl_b32 s58, s55, 10
    s_add_u32 s50, s57, s58
    s_lshl_b32 s56, s56, 3
    s_cmp_ge_u32 s55, 6
    s_cbranch_scc1 kd_49_v
    s_lshr_b32 s57, s55, 1
    s_add_u32 s58, s66, s57
    s_cmp_eq_u32 s57, 2
    s_cselect_b32 s58, s67, s58
    s_add_u32 s58, s58, 80
    s_lshl_b32 s58, s58, 15
    s_lshl_b32 s56, s56, 11
    s_add_u32 s58, s58, s56
    s_and_b32 s57, s55, 1
    s_lshl_b32 s57, s57, 10
    s_add_u32 s58, s58, s57
    s_add_u32 s44, s58, 16777216
    s_mov_b32 s47, 2048
    s_branch kd_49_e
kd_49_v:
    s_mul_i32 s56, s56, 5120
    s_sub_u32 s57, s55, 6
    s_lshl_b32 s57, s57, 10
    s_add_u32 s56, s56, s57
    s_add_u32 s44, s56, s53
    s_mov_b32 s47, 5120
kd_49_e:
    s_add_u32 s44, s44, s47
    s_mul_i32 s55, s32, 3
    s_add_u32 s55, s55, 1
    s_min_u32 s55, s55, 21
    s_cmp_ge_u32 s55, 11
    s_cselect_b32 s56, 1, 0
    s_mul_i32 s57, s56, 11
    s_sub_u32 s55, s55, s57
    s_mul_i32 s57, s56, 11264
    s_lshl_b32 s58, s55, 10
    s_add_u32 s51, s57, s58
    s_lshl_b32 s56, s56, 3
    s_cmp_ge_u32 s55, 6
    s_cbranch_scc1 kd_50_v
    s_lshr_b32 s57, s55, 1
    s_add_u32 s58, s66, s57
    s_cmp_eq_u32 s57, 2
    s_cselect_b32 s58, s67, s58
    s_add_u32 s58, s58, 80
    s_lshl_b32 s58, s58, 15
    s_lshl_b32 s56, s56, 11
    s_add_u32 s58, s58, s56
    s_and_b32 s57, s55, 1
    s_lshl_b32 s57, s57, 10
    s_add_u32 s58, s58, s57
    s_add_u32 s45, s58, 16777216
    s_mov_b32 s48, 2048
    s_branch kd_50_e
kd_50_v:
    s_mul_i32 s56, s56, 5120
    s_sub_u32 s57, s55, 6
    s_lshl_b32 s57, s57, 10
    s_add_u32 s56, s56, s57
    s_add_u32 s45, s56, s53
    s_mov_b32 s48, 5120
kd_50_e:
    s_add_u32 s45, s45, s48
    s_mul_i32 s55, s32, 3
    s_add_u32 s55, s55, 2
    s_min_u32 s55, s55, 21
    s_cmp_ge_u32 s55, 11
    s_cselect_b32 s56, 1, 0
    s_mul_i32 s57, s56, 11
    s_sub_u32 s55, s55, s57
    s_mul_i32 s57, s56, 11264
    s_lshl_b32 s58, s55, 10
    s_add_u32 s52, s57, s58
    s_lshl_b32 s56, s56, 3
    s_cmp_ge_u32 s55, 6
    s_cbranch_scc1 kd_51_v
    s_lshr_b32 s57, s55, 1
    s_add_u32 s58, s66, s57
    s_cmp_eq_u32 s57, 2
    s_cselect_b32 s58, s67, s58
    s_add_u32 s58, s58, 80
    s_lshl_b32 s58, s58, 15
    s_lshl_b32 s56, s56, 11
    s_add_u32 s58, s58, s56
    s_and_b32 s57, s55, 1
    s_lshl_b32 s57, s57, 10
    s_add_u32 s58, s58, s57
    s_add_u32 s46, s58, 16777216
    s_mov_b32 s49, 2048
    s_branch kd_51_e
kd_51_v:
    s_mul_i32 s56, s56, 5120
    s_sub_u32 s57, s55, 6
    s_lshl_b32 s57, s57, 10
    s_add_u32 s56, s56, s57
    s_add_u32 s46, s56, s53
    s_mov_b32 s49, 5120
kd_51_e:
    s_add_u32 s46, s46, s49
    s_barrier
    s_barrier
    s_cmp_eq_u32 s63, 1
    s_cbranch_scc1 eb_52
    s_mov_b32 s54, 13778944
    s_mov_b32 exec_lo, 0xffffff
    s_mov_b32 exec_hi, 0
    buffer_load_dwordx4 v[16:19], v7, s[8:11], s54 offen sc1
    s_waitcnt vmcnt(0)
    v_and_b32 v16, v16, v17
    v_and_b32 v18, v18, v19
    v_and_b32 v16, v16, v18
    v_cmp_eq_u32 vcc, 1, v16
    s_and_b32 s58, vcc_lo, 0xffffff
    s_cmp_eq_u32 s58, 0xffffff
    s_cbranch_scc1 pw_53_ok
    s_mov_b32 s59, 0
pw_53:
    s_sleep 8
    buffer_load_dwordx4 v[16:19], v7, s[8:11], s54 offen sc1
    s_waitcnt vmcnt(0)
    v_and_b32 v16, v16, v17
    v_and_b32 v18, v18, v19
    v_and_b32 v16, v16, v18
    v_cmp_eq_u32 vcc, 1, v16
    s_and_b32 s58, vcc_lo, 0xffffff
    s_cmp_eq_u32 s58, 0xffffff
    s_cbranch_scc1 pw_53_ok
    s_add_u32 s59, s59, 1
    s_cmp_lt_u32 s59, 50000
    s_cbranch_scc1 pw_53
pw_53_ok:
    s_mov_b64 exec, -1
    s_lshr_b32 s56, s35, 1
    s_mul_i32 s57, s56, 11264
    s_add_u32 s57, s57, 0
    s_lshl_b32 s56, s56, 3
    s_add_u32 s56, s56, 0
    s_bitcmp1_b32 s35, 0
    s_cbranch_scc1 sd_54_v
    s_lshl_b32 s56, s56, 11
    s_add_u32 s58, s66, 80
    s_lshl_b32 s58, s58, 15
    s_add_u32 s58, s58, s56
    s_add_u32 s58, s58, 16777216
    s_add_u32 s59, s67, 80
    s_lshl_b32 s59, s59, 15
    s_add_u32 s59, s59, s56
    s_add_u32 s59, s59, 16777216
    s_add_u32 m0, s57, 0
    s_add_u32 s56, s58, 0
    buffer_load_dwordx4 v2, s[8:11], s56 offen sc1 lds
    s_add_u32 m0, s57, 1024
    s_add_u32 s56, s58, 1024
    buffer_load_dwordx4 v2, s[8:11], s56 offen sc1 lds
    s_add_u32 m0, s57, 2048
    s_add_u32 s56, s58, 32768
    buffer_load_dwordx4 v2, s[8:11], s56 offen sc1 lds
    s_add_u32 m0, s57, 3072
    s_add_u32 s56, s58, 33792
    buffer_load_dwordx4 v2, s[8:11], s56 offen sc1 lds
    s_add_u32 m0, s57, 4096
    s_add_u32 s56, s59, 0
    buffer_load_dwordx4 v2, s[8:11], s56 offen sc1 lds
    s_add_u32 m0, s57, 5120
    s_add_u32 s56, s59, 1024
    buffer_load_dwordx4 v2, s[8:11], s56 offen sc1 lds
    s_branch sd_54_e
sd_54_v:
    s_mul_i32 s56, s56, 5120
    s_add_u32 s56, s56, s53
    s_add_u32 m0, s57, 6144
    s_add_u32 s58, s56, 0
    buffer_load_dwordx4 v2, s[8:11], s58 offen sc1 lds
    s_add_u32 m0, s57, 7168
    s_add_u32 s58, s56, 1024
    buffer_load_dwordx4 v2, s[8:11], s58 offen sc1 lds
    s_add_u32 m0, s57, 8192
    s_add_u32 s58, s56, 2048
    buffer_load_dwordx4 v2, s[8:11], s58 offen sc1 lds
    s_add_u32 m0, s57, 9216
    s_add_u32 s58, s56, 3072
    buffer_load_dwordx4 v2, s[8:11], s58 offen sc1 lds
    s_add_u32 m0, s57, 10240
    s_add_u32 s58, s56, 4096
    buffer_load_dwordx4 v2, s[8:11], s58 offen sc1 lds
sd_54_e:
    s_lshl_b32 s56, s34, 8
    s_lshl_b32 s57, s35, 6
    s_add_u32 s56, s56, s57
    s_lshl_b32 s56, s56, 4
    s_add_u32 s56, s56, 16777216
    s_lshl_b32 s57, s35, 10
    s_add_u32 s57, s57, 22528
    s_lshl_b32 s58, s66, 15
    s_add_u32 s58, s58, s56
    s_mov_b32 m0, s57
    s_add_u32 s59, s58, 32768
    buffer_load_dwordx4 v2, s[8:11], s58 offen sc1 lds
    s_add_u32 m0, s57, 4096
    s_lshl_b32 s58, s67, 15
    buffer_load_dwordx4 v2, s[8:11], s59 offen sc1 lds
    s_add_u32 s58, s58, s56
    s_add_u32 s58, s58, s68
    v_lshrrev_b32 v12, 1, v1
    v_lshlrev_b32 v12, 4, v12
    v_and_b32 v13, 1, v1
    v_lshlrev_b32 v13, 2, v13
    v_add_u32 v12, v12, v13
    s_lshl_b32 s57, s35, 9
    s_add_u32 s57, s57, 30720
    s_mov_b32 m0, s57
    s_add_u32 s59, s58, 512
    buffer_load_dword v12, s[8:11], s58 offen sc1 lds
    s_add_u32 m0, s57, 256
    s_nop 0
    buffer_load_dword v12, s[8:11], s59 offen sc1 lds
eb_52:
    s_waitcnt vmcnt(0)
    s_barrier
concat_heads__linear_kernel_hedgehog__mha_block__prompt_kernel_p2entry:
    s_lshl_b32 s56, s35, 10
    s_add_u32 s56, s56, 22528
    v_lshlrev_b32 v133, 12, v131
    v_lshlrev_b32 v134, 4, v3
    v_add3_u32 v133, v133, v134, s56
    s_lshl_b32 s56, s35, 9
    s_add_u32 s56, s56, 30720
    v_add_u32 v134, s56, v132
    v_mov_b32 v12, 0
    v_mov_b32 v13, 0
    v_mov_b32 v14, 0
    v_mov_b32 v15, 0
    ds_read_b128 v[4:7], v133
    ds_read_b128 v[8:11], v133 offset:512
    s_mov_b32 exec_hi, 0
    ds_read_b64 v[12:13], v134
    ds_read_b64 v[14:15], v134 offset:256
    s_mov_b64 exec, -1
    s_waitcnt lgkmcnt(0)
    s_barrier
    s_mov_b32 s61, 22528
    s_add_u32 m0, s61, s50
    s_nop 0
    buffer_load_dwordx4 v2, s[8:11], s44 offen sc1 lds
    s_add_u32 s44, s44, s47
    s_add_u32 m0, s61, s51
    s_nop 0
    buffer_load_dwordx4 v2, s[8:11], s45 offen sc1 lds
    s_add_u32 s45, s45, s48
    s_add_u32 m0, s61, s52
    s_nop 0
    buffer_load_dwordx4 v2, s[8:11], s46 offen sc1 lds
    s_add_u32 s46, s46, s49
    v_mov_b32 v184, 0x3f803f80
    v_cmp_eq_u32 vcc, 20, v3
    s_nop 1
    v_cndmask_b32 v184, 0, v184, vcc
    v_mov_b32 v104, v184
    v_mov_b32 v105, v184
    v_mov_b32 v106, v184
    v_mov_b32 v107, v184
    v_mov_b32 v108, v184
    v_mov_b32 v109, v184
    v_mov_b32 v110, v184
    v_mov_b32 v111, v184
    v_mov_b32 v120, v184
    v_mov_b32 v121, v184
    v_mov_b32 v122, v184
    v_mov_b32 v123, v184
    v_mov_b32 v124, v184
    v_mov_b32 v125, v184
    v_mov_b32 v126, v184
    v_mov_b32 v127, v184
    s_mul_i32 s55, s36, 11264
    v_lshlrev_b32 v184, 11, v131
    v_lshlrev_b32 v185, 4, v3
    v_add3_u32 v128, v184, v185, s55
    s_add_u32 s56, s55, 4096
    s_add_u32 s56, s56, s68
    v_add_u32 v129, s56, v185
    v_mul_u32_u24 v184, 320, v131
    s_add_u32 s56, s55, 6144
    v_add3_u32 v130, v184, v185, s56
    v_add_u32 v133, 22528, v128
    v_add_u32 v134, 22528, v129
    v_add_u32 v135, 22528, v130
    v_mov_b32 v64, 0
    v_mov_b32 v65, 0
    v_mov_b32 v66, 0
    v_mov_b32 v67, 0
    v_mov_b32 v68, 0
    v_mov_b32 v69, 0
    v_mov_b32 v70, 0
    v_mov_b32 v71, 0
    v_mov_b32 v72, 0
    v_mov_b32 v73, 0
    v_mov_b32 v74, 0
    v_mov_b32 v75, 0
    v_mov_b32 v76, 0
    v_mov_b32 v77, 0
    v_mov_b32 v78, 0
    v_mov_b32 v79, 0
    v_mov_b32 v80, 0
    v_mov_b32 v81, 0
    v_mov_b32 v82, 0
    v_mov_b32 v83, 0
    v_mov_b32 v84, 0
    v_mov_b32 v85, 0
    v_mov_b32 v86, 0
    v_mov_b32 v87, 0
    v_mov_b32 v88, 0
    v_mov_b32 v89, 0
    v_mov_b32 v90, 0
    v_mov_b32 v91, 0
    v_mov_b32 v92, 0
    v_mov_b32 v93, 0
    v_mov_b32 v94, 0
    v_mov_b32 v95, 0
    v_mov_b32 v56, 0
    v_mov_b32 v57, 0
    v_mov_b32 v58, 0
    v_mov_b32 v59, 0
    v_mov_b32 v60, 0
    v_mov_b32 v61, 0
    v_mov_b32 v62, 0
    v_mov_b32 v63, 0
    s_mov_b32 s62, 0x44
    s_mov_b32 s63, 0x44
    s_cmp_eq_u32 s36, 1
    s_cselect_b32 s56, 0xa0, 0
    s_cselect_b32 s55, 0x80, 0
    s_or_b32 s63, s63, s56
    s_or_b32 s62, s62, s55
    s_cmp_eq_u32 s32, 0
    s_cselect_b32 s56, 0x2, 0
    s_or_b32 s62, s62, s56
    s_or_b32 s63, s63, s56
    s_cmp_lt_u32 s32, 5
    s_cselect_b32 s55, 0x38, 0
    s_cselect_b32 s56, 0x18, 0
    s_or_b32 s62, s62, s55
    s_or_b32 s63, s63, s56
    s_cmp_eq_u32 s32, 0
    s_cselect_b32 s55, 1, 0
    s_andn2_b32 s55, s55, s31
    s_or_b32 s62, s62, s55
    ds_read_b128 v[112:115], v128 offset:0
    ds_read_b64 v[116:117], v129 offset:0
    ds_read_b128 v[96:99], v128 offset:512
    ds_read_b64 v[100:101], v129 offset:512
    s_mov_b64 exec, s[42:43]
    ds_read_b128 v[104:107], v130 offset:0
    ds_read_b128 v[108:111], v130 offset:640
    s_mov_b64 exec, -1
    s_waitcnt lgkmcnt(0)
    v_mfma_f32_32x32x16_bf16 v[16:31], v[112:115], v[4:7], 0
    v_mfma_f32_32x32x8_bf16 v[16:31], v[116:117], v[12:13], v[16:31]
    s_nop 7
    v_mfma_f32_32x32x16_bf16 v[32:47], v[112:115], v[8:11], 0
    s_nop 2
    v_exp_f32 v16, v16
    v_exp_f32 v17, v17
    v_exp_f32 v18, v18
    v_exp_f32 v19, v19
    v_mfma_f32_32x32x8_bf16 v[32:47], v[116:117], v[14:15], v[32:47]
    v_exp_f32 v20, v20
    v_exp_f32 v21, v21
    v_exp_f32 v22, v22
    v_exp_f32 v23, v23
    v_cvt_pk_bf16_f32 v48, v16, v17
    v_cvt_pk_bf16_f32 v49, v18, v19
    v_exp_f32 v24, v24
    v_exp_f32 v25, v25
    v_exp_f32 v26, v26
    v_exp_f32 v27, v27
    v_cvt_pk_bf16_f32 v50, v20, v21
    v_cvt_pk_bf16_f32 v51, v22, v23
    v_exp_f32 v28, v28
    v_exp_f32 v29, v29
    v_exp_f32 v30, v30
    v_exp_f32 v31, v31
    v_cvt_pk_bf16_f32 v52, v24, v25
    v_cvt_pk_bf16_f32 v53, v26, v27
    v_cvt_pk_bf16_f32 v54, v28, v29
    v_cvt_pk_bf16_f32 v55, v30, v31
    s_mov_b32 s60, 0
    s_mov_b32 s61, 22528
concat_heads__linear_kernel_hedgehog__mha_block__prompt_kernel_stage:
    s_waitcnt lgkmcnt(0)
    s_setprio 1
    v_mfma_f32_32x32x16_bf16 v[16:31], v[96:99], v[4:7], 0
    ds_read_b128 v[112:115], v128 offset:1024
    ds_read_b64 v[116:117], v129 offset:1024
    v_exp_f32 v32, v32
    v_exp_f32 v33, v33
    v_exp_f32 v34, v34
    v_exp_f32 v35, v35
    v_mfma_f32_32x32x8_bf16 v[16:31], v[100:101], v[12:13], v[16:31]
    s_mov_b64 exec, s[42:43]
    ds_read_b128 v[120:123], v130 offset:1280
    ds_read_b128 v[124:127], v130 offset:1920
    s_mov_b64 exec, -1
    v_exp_f32 v36, v36
    v_exp_f32 v37, v37
    v_exp_f32 v38, v38
    v_exp_f32 v39, v39
    v_cvt_pk_bf16_f32 v56, v32, v33
    v_cvt_pk_bf16_f32 v57, v34, v35
    v_mfma_f32_32x32x16_bf16 v[64:79], v[104:107], v[48:51], v[64:79]
    v_exp_f32 v40, v40
    v_exp_f32 v41, v41
    v_exp_f32 v42, v42
    v_exp_f32 v43, v43
    v_cvt_pk_bf16_f32 v58, v36, v37
    v_cvt_pk_bf16_f32 v59, v38, v39
    v_mfma_f32_32x32x16_bf16 v[64:79], v[108:111], v[52:55], v[64:79]
    v_exp_f32 v44, v44
    v_exp_f32 v45, v45
    v_exp_f32 v46, v46
    v_exp_f32 v47, v47
    v_cvt_pk_bf16_f32 v60, v40, v41
    v_cvt_pk_bf16_f32 v61, v42, v43
    v_cvt_pk_bf16_f32 v62, v44, v45
    v_cvt_pk_bf16_f32 v63, v46, v47
    s_setprio 0
    v_mfma_f32_32x32x16_bf16 v[32:47], v[96:99], v[8:11], 0
    v_exp_f32 v16, v16
    v_exp_f32 v17, v17
    v_exp_f32 v18, v18
    v_exp_f32 v19, v19
    v_mfma_f32_32x32x8_bf16 v[32:47], v[100:101], v[14:15], v[32:47]
    v_exp_f32 v20, v20
    v_exp_f32 v21, v21
    v_exp_f32 v22, v22
    v_exp_f32 v23, v23
    v_cvt_pk_bf16_f32 v48, v16, v17
    v_cvt_pk_bf16_f32 v49, v18, v19
    v_mfma_f32_32x32x16_bf16 v[80:95], v[104:107], v[56:59], v[80:95]
    v_exp_f32 v24, v24
    v_exp_f32 v25, v25
    v_exp_f32 v26, v26
    v_exp_f32 v27, v27
    v_cvt_pk_bf16_f32 v50, v20, v21
    v_cvt_pk_bf16_f32 v51, v22, v23
    v_mfma_f32_32x32x16_bf16 v[80:95], v[108:111], v[60:63], v[80:95]
    v_exp_f32 v28, v28
    v_exp_f32 v29, v29
    v_exp_f32 v30, v30
    v_exp_f32 v31, v31
    v_cvt_pk_bf16_f32 v52, v24, v25
    v_cvt_pk_bf16_f32 v53, v26, v27
    v_cvt_pk_bf16_f32 v54, v28, v29
    v_cvt_pk_bf16_f32 v55, v30, v31
    s_waitcnt lgkmcnt(0)
    s_waitcnt vmcnt(0)
    s_barrier
    s_bitcmp1_b32 s62, s60
    s_cbranch_scc1 concat_heads__linear_kernel_hedgehog__mha_block__prompt_kernel_hk1
concat_heads__linear_kernel_hedgehog__mha_block__prompt_kernel_rt1:
    s_setprio 1
    v_mfma_f32_32x32x16_bf16 v[16:31], v[112:115], v[4:7], 0
    ds_read_b128 v[96:99], v128 offset:1536
    ds_read_b64 v[100:101], v129 offset:1536
    v_exp_f32 v32, v32
    v_exp_f32 v33, v33
    v_exp_f32 v34, v34
    v_exp_f32 v35, v35
    v_mfma_f32_32x32x8_bf16 v[16:31], v[116:117], v[12:13], v[16:31]
    s_mov_b64 exec, s[42:43]
    ds_read_b128 v[104:107], v130 offset:2560
    ds_read_b128 v[108:111], v130 offset:3200
    s_mov_b64 exec, -1
    v_exp_f32 v36, v36
    v_exp_f32 v37, v37
    v_exp_f32 v38, v38
    v_exp_f32 v39, v39
    v_cvt_pk_bf16_f32 v56, v32, v33
    v_cvt_pk_bf16_f32 v57, v34, v35
    v_mfma_f32_32x32x16_bf16 v[64:79], v[120:123], v[48:51], v[64:79]
    v_exp_f32 v40, v40
    v_exp_f32 v41, v41
    v_exp_f32 v42, v42
    v_exp_f32 v43, v43
    v_cvt_pk_bf16_f32 v58, v36, v37
    v_cvt_pk_bf16_f32 v59, v38, v39
    v_mfma_f32_32x32x16_bf16 v[64:79], v[124:127], v[52:55], v[64:79]
    v_exp_f32 v44, v44
    v_exp_f32 v45, v45
    v_exp_f32 v46, v46
    v_exp_f32 v47, v47
    v_cvt_pk_bf16_f32 v60, v40, v41
    v_cvt_pk_bf16_f32 v61, v42, v43
    v_cvt_pk_bf16_f32 v62, v44, v45
    v_cvt_pk_bf16_f32 v63, v46, v47
    s_setprio 0
    v_mfma_f32_32x32x16_bf16 v[32:47], v[112:115], v[8:11], 0
    v_exp_f32 v16, v16
    v_exp_f32 v17, v17
    v_exp_f32 v18, v18
    v_exp_f32 v19, v19
    v_mfma_f32_32x32x8_bf16 v[32:47], v[116:117], v[14:15], v[32:47]
    v_exp_f32 v20, v20
    v_exp_f32 v21, v21
    v_exp_f32 v22, v22
    v_exp_f32 v23, v23
    v_cvt_pk_bf16_f32 v48, v16, v17
    v_cvt_pk_bf16_f32 v49, v18, v19
    v_mfma_f32_32x32x16_bf16 v[80:95], v[120:123], v[56:59], v[80:95]
    v_exp_f32 v24, v24
    v_exp_f32 v25, v25
    v_exp_f32 v26, v26
    v_exp_f32 v27, v27
    v_cvt_pk_bf16_f32 v50, v20, v21
    v_cvt_pk_bf16_f32 v51, v22, v23
    v_mfma_f32_32x32x16_bf16 v[80:95], v[124:127], v[60:63], v[80:95]
    v_exp_f32 v28, v28
    v_exp_f32 v29, v29
    v_exp_f32 v30, v30
    v_exp_f32 v31, v31
    v_cvt_pk_bf16_f32 v52, v24, v25
    v_cvt_pk_bf16_f32 v53, v26, v27
    v_cvt_pk_bf16_f32 v54, v28, v29
    v_cvt_pk_bf16_f32 v55, v30, v31
    s_waitcnt lgkmcnt(0)
    s_cmp_lt_u32 s60, 6
    s_cbranch_scc0 concat_heads__linear_kernel_hedgehog__mha_block__prompt_kernel_nodma
    s_add_u32 s61, s61, 22528
    s_cmp_eq_u32 s61, 90112
    s_cselect_b32 s61, 0, s61
    s_add_u32 m0, s61, s50
    s_nop 0
    buffer_load_dwordx4 v2, s[8:11], s44 offen sc1 lds
    s_add_u32 s44, s44, s47
    s_add_u32 m0, s61, s51
    s_nop 0
    buffer_load_dwordx4 v2, s[8:11], s45 offen sc1 lds
    s_add_u32 s45, s45, s48
    s_add_u32 m0, s61, s52
    s_nop 0
    buffer_load_dwordx4 v2, s[8:11], s46 offen sc1 lds
    s_add_u32 s46, s46, s49
concat_heads__linear_kernel_hedgehog__mha_block__prompt_kernel_nodma:
    s_setprio 1
    v_mfma_f32_32x32x16_bf16 v[16:31], v[96:99], v[4:7], 0
    ds_read_b128 v[112:115], v133 offset:0
    ds_read_b64 v[116:117], v134 offset:0
    v_exp_f32 v32, v32
    v_exp_f32 v33, v33
    v_exp_f32 v34, v34
    v_exp_f32 v35, v35
    v_mfma_f32_32x32x8_bf16 v[16:31], v[100:101], v[12:13], v[16:31]
    s_mov_b64 exec, s[42:43]
    ds_read_b128 v[120:123], v130 offset:3840
    ds_read_b128 v[124:127], v130 offset:4480
    s_mov_b64 exec, -1
    v_exp_f32 v36, v36
    v_exp_f32 v37, v37
    v_exp_f32 v38, v38
    v_exp_f32 v39, v39
    v_cvt_pk_bf16_f32 v56, v32, v33
    v_cvt_pk_bf16_f32 v57, v34, v35
    v_mfma_f32_32x32x16_bf16 v[64:79], v[104:107], v[48:51], v[64:79]
    v_exp_f32 v40, v40
    v_exp_f32 v41, v41
    v_exp_f32 v42, v42
    v_exp_f32 v43, v43
    v_cvt_pk_bf16_f32 v58, v36, v37
    v_cvt_pk_bf16_f32 v59, v38, v39
    v_mfma_f32_32x32x16_bf16 v[64:79], v[108:111], v[52:55], v[64:79]
    v_exp_f32 v44, v44
    v_exp_f32 v45, v45
    v_exp_f32 v46, v46
    v_exp_f32 v47, v47
    v_cvt_pk_bf16_f32 v60, v40, v41
    v_cvt_pk_bf16_f32 v61, v42, v43
    v_cvt_pk_bf16_f32 v62, v44, v45
    v_cvt_pk_bf16_f32 v63, v46, v47
    s_setprio 0
    v_mfma_f32_32x32x16_bf16 v[32:47], v[96:99], v[8:11], 0
    v_exp_f32 v16, v16
    v_exp_f32 v17, v17
    v_exp_f32 v18, v18
    v_exp_f32 v19, v19
    v_mfma_f32_32x32x8_bf16 v[32:47], v[100:101], v[14:15], v[32:47]
    v_exp_f32 v20, v20
    v_exp_f32 v21, v21
    v_exp_f32 v22, v22
    v_exp_f32 v23, v23
    v_cvt_pk_bf16_f32 v48, v16, v17
    v_cvt_pk_bf16_f32 v49, v18, v19
    v_mfma_f32_32x32x16_bf16 v[80:95], v[104:107], v[56:59], v[80:95]
    v_exp_f32 v24, v24
    v_exp_f32 v25, v25
    v_exp_f32 v26, v26
    v_exp_f32 v27, v27
    v_cvt_pk_bf16_f32 v50, v20, v21
    v_cvt_pk_bf16_f32 v51, v22, v23
    v_mfma_f32_32x32x16_bf16 v[80:95], v[108:111], v[60:63], v[80:95]
    v_exp_f32 v28, v28
    v_exp_f32 v29, v29
    v_exp_f32 v30, v30
    v_exp_f32 v31, v31
    v_cvt_pk_bf16_f32 v52, v24, v25
    v_cvt_pk_bf16_f32 v53, v26, v27
    v_cvt_pk_bf16_f32 v54, v28, v29
    v_cvt_pk_bf16_f32 v55, v30, v31
    s_waitcnt lgkmcnt(0)
    s_bitcmp1_b32 s63, s60
    s_cbranch_scc1 concat_heads__linear_kernel_hedgehog__mha_block__prompt_kernel_hk3
concat_heads__linear_kernel_hedgehog__mha_block__prompt_kernel_rt3:
    s_setprio 1
    v_mfma_f32_32x32x16_bf16 v[16:31], v[112:115], v[4:7], 0
    ds_read_b128 v[96:99], v133 offset:512
    ds_read_b64 v[100:101], v134 offset:512
    v_exp_f32 v32, v32
    v_exp_f32 v33, v33
    v_exp_f32 v34, v34
    v_exp_f32 v35, v35
    v_mfma_f32_32x32x8_bf16 v[16:31], v[116:117], v[12:13], v[16:31]
    s_mov_b64 exec, s[42:43]
    ds_read_b128 v[104:107], v135 offset:0
    ds_read_b128 v[108:111], v135 offset:640
    s_mov_b64 exec, -1
    v_exp_f32 v36, v36
    v_exp_f32 v37, v37
    v_exp_f32 v38, v38
    v_exp_f32 v39, v39
    v_cvt_pk_bf16_f32 v56, v32, v33
    v_cvt_pk_bf16_f32 v57, v34, v35
    v_mfma_f32_32x32x16_bf16 v[64:79], v[120:123], v[48:51], v[64:79]
    v_exp_f32 v40, v40
    v_exp_f32 v41, v41
    v_exp_f32 v42, v42
    v_exp_f32 v43, v43
    v_cvt_pk_bf16_f32 v58, v36, v37
    v_cvt_pk_bf16_f32 v59, v38, v39
    v_mfma_f32_32x32x16_bf16 v[64:79], v[124:127], v[52:55], v[64:79]
    v_exp_f32 v44, v44
    v_exp_f32 v45, v45
    v_exp_f32 v46, v46
    v_exp_f32 v47, v47
    v_cvt_pk_bf16_f32 v60, v40, v41
    v_cvt_pk_bf16_f32 v61, v42, v43
    v_cvt_pk_bf16_f32 v62, v44, v45
    v_cvt_pk_bf16_f32 v63, v46, v47
    s_setprio 0
    s_cmp_eq_u32 s60, 7
    s_cbranch_scc1 concat_heads__linear_kernel_hedgehog__mha_block__prompt_kernel_tail
    v_mfma_f32_32x32x16_bf16 v[32:47], v[112:115], v[8:11], 0
    v_exp_f32 v16, v16
    v_exp_f32 v17, v17
    v_exp_f32 v18, v18
    v_exp_f32 v19, v19
    v_mfma_f32_32x32x8_bf16 v[32:47], v[116:117], v[14:15], v[32:47]
    v_exp_f32 v20, v20
    v_exp_f32 v21, v21
    v_exp_f32 v22, v22
    v_exp_f32 v23, v23
    v_cvt_pk_bf16_f32 v48, v16, v17
    v_cvt_pk_bf16_f32 v49, v18, v19
    v_mfma_f32_32x32x16_bf16 v[80:95], v[120:123], v[56:59], v[80:95]
    v_exp_f32 v24, v24
    v_exp_f32 v25, v25
    v_exp_f32 v26, v26
    v_exp_f32 v27, v27
    v_cvt_pk_bf16_f32 v50, v20, v21
    v_cvt_pk_bf16_f32 v51, v22, v23
    v_mfma_f32_32x32x16_bf16 v[80:95], v[124:127], v[60:63], v[80:95]
    v_exp_f32 v28, v28
    v_exp_f32 v29, v29
    v_exp_f32 v30, v30
    v_exp_f32 v31, v31
    v_cvt_pk_bf16_f32 v52, v24, v25
    v_cvt_pk_bf16_f32 v53, v26, v27
    v_cvt_pk_bf16_f32 v54, v28, v29
    v_cvt_pk_bf16_f32 v55, v30, v31
    v_mov_b32 v128, v133
    v_mov_b32 v129, v134
    v_mov_b32 v130, v135
    s_add_u32 s60, s60, 1
    s_and_b32 s55, s60, 3
    s_cmp_eq_u32 s55, 3
    s_mov_b32 s55, 22528
    s_cselect_b32 s55, 0xfffef800, s55
    v_add_u32 v133, s55, v133
    v_add_u32 v134, s55, v134
    v_add_u32 v135, s55, v135
    s_branch concat_heads__linear_kernel_hedgehog__mha_block__prompt_kernel_stage
concat_heads__linear_kernel_hedgehog__mha_block__prompt_kernel_hk1:
    s_cmp_eq_u32 s60, 0
    s_cbranch_scc1 concat_heads__linear_kernel_hedgehog__mha_block__prompt_kernel_h10
    s_cmp_eq_u32 s60, 1
    s_cbranch_scc1 concat_heads__linear_kernel_hedgehog__mha_block__prompt_kernel_h11
    s_cmp_eq_u32 s60, 2
    s_cbranch_scc1 concat_heads__linear_kernel_hedgehog__mha_block__prompt_kernel_h21
    s_cmp_eq_u32 s60, 3
    s_cbranch_scc1 concat_heads__linear_kernel_hedgehog__mha_block__prompt_kernel_h31
    s_cmp_eq_u32 s60, 4
    s_cbranch_scc1 concat_heads__linear_kernel_hedgehog__mha_block__prompt_kernel_h41
    s_cmp_eq_u32 s60, 5
    s_cbranch_scc1 concat_heads__linear_kernel_hedgehog__mha_block__prompt_kernel_h51
    s_cmp_eq_u32 s60, 6
    s_cbranch_scc1 concat_heads__linear_kernel_hedgehog__mha_block__prompt_kernel_h61
    s_cmp_eq_u32 s60, 7
    s_cbranch_scc1 concat_heads__linear_kernel_hedgehog__mha_block__prompt_kernel_h71
    s_branch concat_heads__linear_kernel_hedgehog__mha_block__prompt_kernel_rt1
concat_heads__linear_kernel_hedgehog__mha_block__prompt_kernel_h10:
    s_lshl_b32 s55, s38, 7
    s_lshl_b32 s56, s37, 2
    s_add_u32 s55, s55, s56
    s_add_u32 s55, s55, 13783040
    v_mov_b32 v184, 0
    v_mov_b32 v185, 1
    s_mov_b64 exec, 1
    buffer_store_dword v185, v184, s[8:11], s55 offen sc1
    s_mov_b64 exec, -1
    s_branch concat_heads__linear_kernel_hedgehog__mha_block__prompt_kernel_rt1
concat_heads__linear_kernel_hedgehog__mha_block__prompt_kernel_h11:
    s_mov_b32 s55, 13783040
    s_mul_i32 s56, s33, 20
    s_add_u32 s57, s56, 19
    s_lshr_b32 s56, s56, 7
    s_lshr_b32 s57, s57, 7
    v_lshrrev_b32 v188, 3, v1
    v_min_u32 v188, 2, v188
    v_mul_u32_u24 v188, 5, v188
    v_bfe_u32 v189, v1, 2, 1
    v_cmp_eq_u32 vcc, 1, v189
    v_mov_b32 v189, s56
    v_mov_b32 v190, s57
    v_cndmask_b32 v189, v189, v190, vcc
    v_add_u32 v188, v188, v189
    v_lshlrev_b32 v188, 7, v188
    v_and_b32 v189, 3, v1
    v_lshlrev_b32 v189, 4, v189
    v_add_u32 v188, v188, v189
    s_mov_b32 exec_lo, 0xffffff
    s_mov_b32 exec_hi, 0
    buffer_load_dwordx4 v[248:251], v188, s[8:11], s55 offen sc1
    s_mov_b64 exec, -1
    s_branch concat_heads__linear_kernel_hedgehog__mha_block__prompt_kernel_rt1
concat_heads__linear_kernel_hedgehog__mha_block__prompt_kernel_h21:
    v_lshlrev_b32 v184, 15, v131
    v_lshlrev_b32 v185, 4, v3
    v_add_u32 v184, v184, v185
    v_add_u32 v185, s68, v185
    s_lshl_b32 s56, s34, 8
    s_lshl_b32 s57, s32, 5
    s_add_u32 s57, s57, s56
    s_lshl_b32 s57, s57, 4
    s_add_u32 s57, s57, 0
    s_add_u32 s58, s66, 80
    s_lshl_b32 s58, s58, 15
    s_add_u32 s58, s58, s57
    buffer_load_dwordx4 v[148:151], v184, s[8:11], s58 offen sc1
    s_add_u32 s58, s67, 80
    s_lshl_b32 s58, s58, 15
    s_add_u32 s58, s58, s57
    buffer_load_dwordx2 v[152:153], v185, s[8:11], s58 offen sc1
    s_lshl_b32 s57, s35, 1
    s_add_u32 s57, s57, s36
    s_lshl_b32 s57, s57, 5
    s_add_u32 s57, s57, s56
    s_lshl_b32 s57, s57, 4
    s_add_u32 s57, s57, 0
    s_lshl_b32 s58, s66, 15
    s_add_u32 s58, s58, s57
    buffer_load_dwordx4 v[180:183], v184, s[8:11], s58 offen sc1
    s_lshl_b32 s58, s67, 15
    s_add_u32 s58, s58, s57
    buffer_load_dwordx2 v[154:155], v185, s[8:11], s58 offen sc1
    v_mov_b32 v186, 0x3f803f80
    v_cmp_eq_u32 vcc, 20, v3
    s_nop 1
    v_cndmask_b32 v186, 0, v186, vcc
    v_mov_b32 v156, v186
    v_mov_b32 v157, v186
    v_mov_b32 v158, v186
    v_mov_b32 v159, v186
    v_mov_b32 v160, v186
    v_mov_b32 v161, v186
    v_mov_b32 v162, v186
    v_mov_b32 v163, v186
    v_mul_u32_u24 v186, 320, v131
    v_lshlrev_b32 v187, 4, v3
    v_add_u32 v186, v186, v187
    s_lshl_b32 s56, s34, 1
    s_lshr_b32 s57, s32, 2
    s_add_u32 s56, s56, s57
    s_mul_i32 s56, s56, 5120
    s_and_b32 s57, s32, 3
    s_mul_i32 s57, s57, 1280
    s_add_u32 s56, s56, s57
    s_mul_i32 s57, s33, 81920
    s_add_u32 s56, s56, s57
    s_add_u32 s56, s56, 5242880
    s_mov_b64 exec, s[42:43]
    buffer_load_dwordx4 v[156:159], v186, s[8:11], s56 offen sc1
    buffer_load_dwordx4 v[160:163], v186, s[8:11], s56 offen offset:640 sc1
    s_mov_b64 exec, -1
    v_lshlrev_b32 v187, 3, v1
    s_mul_i32 s56, s33, 1536
    s_add_u32 s56, s56, 13631488
    buffer_load_dwordx4 v[164:167], v2, s[8:11], s56 offen sc1
    buffer_load_dwordx2 v[168:169], v187, s[8:11], s56 offen offset:1024 sc1
    s_mov_b32 s56, 13697024
    buffer_load_dwordx4 v[172:175], v2, s[8:11], s56 offen sc1
    buffer_load_dwordx2 v[176:177], v187, s[8:11], s56 offen offset:1024 sc1
    s_branch concat_heads__linear_kernel_hedgehog__mha_block__prompt_kernel_rt1
concat_heads__linear_kernel_hedgehog__mha_block__prompt_kernel_h31:
    s_lshl_b32 s55, s32, 10
    s_add_u32 s55, s55, 98304
    v_add_u32 v184, s55, v2
    ds_read_b128 v[192:195], v184 offset:0
    ds_read_b128 v[196:199], v184 offset:5120
    ds_read_b128 v[200:203], v184 offset:10240
    ds_read_b128 v[204:207], v184 offset:15360
    ds_read_b128 v[208:211], v184 offset:20480
    ds_read_b128 v[212:215], v184 offset:25600
    ds_read_b128 v[216:219], v184 offset:30720
    ds_read_b128 v[220:223], v184 offset:35840
    s_mul_i32 s55, s33, 40960
    s_mul_i32 s56, s34, 5120
    s_add_u32 s55, s55, s56
    s_lshl_b32 s56, s32, 10
    s_add_u32 s55, s55, s56
    s_add_u32 s55, s55, 11534336
    s_waitcnt lgkmcnt(0)
    v_add_f32 v192, v192, v196
    v_add_f32 v193, v193, v197
    v_add_f32 v194, v194, v198
    v_add_f32 v195, v195, v199
    v_add_f32 v192, v192, v200
    v_add_f32 v193, v193, v201
    v_add_f32 v194, v194, v202
    v_add_f32 v195, v195, v203
    v_add_f32 v192, v192, v204
    v_add_f32 v193, v193, v205
    v_add_f32 v194, v194, v206
    v_add_f32 v195, v195, v207
    v_add_f32 v192, v192, v208
    v_add_f32 v193, v193, v209
    v_add_f32 v194, v194, v210
    v_add_f32 v195, v195, v211
    v_add_f32 v192, v192, v212
    v_add_f32 v193, v193, v213
    v_add_f32 v194, v194, v214
    v_add_f32 v195, v195, v215
    v_add_f32 v192, v192, v216
    v_add_f32 v193, v193, v217
    v_add_f32 v194, v194, v218
    v_add_f32 v195, v195, v219
    v_add_f32 v192, v192, v220
    v_add_f32 v193, v193, v221
    v_add_f32 v194, v194, v222
    v_add_f32 v195, v195, v223
    buffer_store_dwordx4 v[192:195], v2, s[8:11], s55 offen sc1
    s_branch concat_heads__linear_kernel_hedgehog__mha_block__prompt_kernel_rt1
concat_heads__linear_kernel_hedgehog__mha_block__prompt_kernel_h41:
    s_cmp_ge_u32 s32, 5
    s_cbranch_scc1 concat_heads__linear_kernel_hedgehog__mha_block__prompt_kernel_h41b
    s_lshl_b32 s55, s33, 8
    s_lshl_b32 s56, s32, 5
    s_add_u32 s55, s55, s56
    s_add_u32 s55, s55, 13787136
    v_lshlrev_b32 v188, 2, v1
    buffer_load_dword v248, v188, s[8:11], s55 offen sc1
concat_heads__linear_kernel_hedgehog__mha_block__prompt_kernel_h41b:
    s_branch concat_heads__linear_kernel_hedgehog__mha_block__prompt_kernel_rt1
concat_heads__linear_kernel_hedgehog__mha_block__prompt_kernel_h51:
    s_cmp_ge_u32 s32, 5
    s_cbranch_scc1 concat_heads__linear_kernel_hedgehog__mha_block__prompt_kernel_rt1
    v_add_f32 v148, v148, v152
    v_add_f32 v149, v149, v153
    v_add_f32 v150, v150, v154
    v_add_f32 v151, v151, v155
    v_add_f32 v148, v148, v156
    v_add_f32 v149, v149, v157
    v_add_f32 v150, v150, v158
    v_add_f32 v151, v151, v159
    v_add_f32 v148, v148, v160
    v_add_f32 v149, v149, v161
    v_add_f32 v150, v150, v162
    v_add_f32 v151, v151, v163
    v_add_f32 v148, v148, v164
    v_add_f32 v149, v149, v165
    v_add_f32 v150, v150, v166
    v_add_f32 v151, v151, v167
    v_add_f32 v148, v148, v168
    v_add_f32 v149, v149, v169
    v_add_f32 v150, v150, v170
    v_add_f32 v151, v151, v171
    v_add_f32 v148, v148, v172
    v_add_f32 v149, v149, v173
    v_add_f32 v150, v150, v174
    v_add_f32 v151, v151, v175
    v_add_f32 v148, v148, v176
    v_add_f32 v149, v149, v177
    v_add_f32 v150, v150, v178
    v_add_f32 v151, v151, v179
    v_cvt_pk_bf16_f32 v192, v148, v149
    v_cvt_pk_bf16_f32 v193, v150, v151
    s_cmp_eq_u32 s32, 2
    s_cbranch_scc1 concat_heads__linear_kernel_hedgehog__mha_block__prompt_kernel_kv2
    s_cmp_ge_u32 s32, 3
    s_cselect_b32 s55, 1024, 0
    s_cmp_eq_u32 s32, 1
    s_cselect_b32 s56, 8, 0
    s_cmp_eq_u32 s32, 4
    s_cselect_b32 s56, 8, s56
    s_add_u32 s55, s55, s56
    s_add_u32 s55, s55, 90112
    v_add_u32 v185, s55, v2
    ds_write_b64 v185, v[192:193]
    s_branch concat_heads__linear_kernel_hedgehog__mha_block__prompt_kernel_rt1
concat_heads__linear_kernel_hedgehog__mha_block__prompt_kernel_kv2:
    v_mov_b32 v194, v193
    v_mov_b32 v193, 0
    v_mov_b32 v195, 0
    v_lshlrev_b32 v185, 3, v1
    v_add_u32 v185, 92160, v185
    ds_write_b64 v185, v[192:193]
    ds_write_b64 v185, v[194:195] offset:512
    s_branch concat_heads__linear_kernel_hedgehog__mha_block__prompt_kernel_rt1
concat_heads__linear_kernel_hedgehog__mha_block__prompt_kernel_h61:
    v_add_u32 v185, 90112, v2
    v_lshlrev_b32 v186, 3, v1
    v_add_u32 v186, 92160, v186
    ds_read_b128 v[208:211], v185
    ds_read_b128 v[212:215], v185 offset:1024
    ds_read_b64 v[216:217], v186
    ds_read_b64 v[218:219], v186 offset:512
    s_waitcnt lgkmcnt(0)
    v_mfma_f32_32x32x16_bf16 v[192:207], v[208:211], v[136:139], 0
    v_mfma_f32_32x32x8_bf16 v[192:207], v[216:217], v[140:141], v[192:207]
    v_mfma_f32_32x32x16_bf16 v[192:207], v[212:215], v[142:145], v[192:207]
    v_mfma_f32_32x32x8_bf16 v[192:207], v[218:219], v[146:147], v[192:207]
    s_mul_i32 s55, s33, 20
    v_lshlrev_b32 v186, 2, v131
    v_add_u32 v186, s55, v186
    v_and_b32 v187, 7, v186
    v_lshlrev_b32 v187, 1, v187
    v_lshrrev_b32 v186, 3, v186
    v_lshlrev_b32 v186, 10, v186
    v_add_u32 v186, v186, v187
    s_lshl_b32 s55, s36, 5
    v_add_u32 v187, s55, v3
    v_lshlrev_b32 v187, 4, v187
    v_add_u32 v186, v186, v187
    s_lshl_b32 s55, s34, 2
    s_add_u32 s55, s55, s35
    s_mul_i32 s55, s55, 81920
    s_add_u32 s55, s55, 8388608
    v_mov_b32 v208, v200
    v_mov_b32 v209, v200
    s_nop 1
    v_permlane32_swap_b32 v208, v209
    v_add_f32 v209, 0x358637bd, v209
    v_rcp_f32 v209, v209
    s_nop 0
    v_mul_f32 v192, v192, v209
    v_mul_f32 v193, v193, v209
    v_mul_f32 v194, v194, v209
    v_mul_f32 v195, v195, v209
    v_mul_f32 v196, v196, v209
    v_mul_f32 v197, v197, v209
    v_mul_f32 v198, v198, v209
    v_mul_f32 v199, v199, v209
    v_mul_f32 v200, v200, v209
    v_mul_f32 v201, v201, v209
    v_mul_f32 v202, v202, v209
    v_mul_f32 v203, v203, v209
    v_cvt_pk_bf16_f32 v210, v192, v193
    v_cvt_pk_bf16_f32 v211, v194, v195
    v_cvt_pk_bf16_f32 v212, v196, v197
    v_cvt_pk_bf16_f32 v213, v198, v199
    v_cvt_pk_bf16_f32 v214, v200, v201
    v_cvt_pk_bf16_f32 v215, v202, v203
    buffer_store_dwordx2 v[210:211], v186, s[8:11], s55 offen sc1
    buffer_store_dwordx2 v[212:213], v186, s[8:11], s55 offen offset:1024 sc1
    s_mov_b32 exec_hi, 0
    buffer_store_dwordx2 v[214:215], v186, s[8:11], s55 offen offset:2048 sc1
    s_mov_b64 exec, -1
    s_branch concat_heads__linear_kernel_hedgehog__mha_block__prompt_kernel_rt1
concat_heads__linear_kernel_hedgehog__mha_block__prompt_kernel_hk3:
    s_cmp_eq_u32 s60, 1
    s_cbranch_scc1 concat_heads__linear_kernel_hedgehog__mha_block__prompt_kernel_h13
    s_cmp_eq_u32 s60, 2
    s_cbranch_scc1 concat_heads__linear_kernel_hedgehog__mha_block__prompt_kernel_h23
    s_cmp_eq_u32 s60, 3
    s_cbranch_scc1 concat_heads__linear_kernel_hedgehog__mha_block__prompt_kernel_h33
    s_cmp_eq_u32 s60, 4
    s_cbranch_scc1 concat_heads__linear_kernel_hedgehog__mha_block__prompt_kernel_h43
    s_cmp_eq_u32 s60, 5
    s_cbranch_scc1 concat_heads__linear_kernel_hedgehog__mha_block__prompt_kernel_h53
    s_cmp_eq_u32 s60, 6
    s_cbranch_scc1 concat_heads__linear_kernel_hedgehog__mha_block__prompt_kernel_h63
    s_cmp_eq_u32 s60, 7
    s_cbranch_scc1 concat_heads__linear_kernel_hedgehog__mha_block__prompt_kernel_h73
    s_branch concat_heads__linear_kernel_hedgehog__mha_block__prompt_kernel_rt3
concat_heads__linear_kernel_hedgehog__mha_block__prompt_kernel_h53:
    v_lshlrev_b32 v191, 2, v1
    s_mul_i32 s94, s33, 81920
    s_add_u32 s94, s94, 8388608
    s_lshl_b32 s55, s35, 10
    s_add_u32 s94, s94, s55
    s_mul_i32 s95, s34, 102400
    s_add_u32 s95, s95, 14680064
    s_add_u32 s95, s95, s55
    s_lshl_b32 s55, s34, 13
    s_add_u32 s94, s94, s55
    s_mul_i32 s55, s34, 10240
    s_add_u32 s95, s95, s55
    s_sub_u32 s100, 10, s34
    s_lshl_b32 s56, s35, 10
    s_add_u32 s56, s56, 98304
    s_cmp_le_u32 s100, 0
    s_cselect_b32 s58, 102400, 0
    s_add_u32 s57, s95, 0
    s_sub_u32 s57, s57, s58
    s_add_u32 m0, s56, 8192
    s_add_u32 s58, s57, 4096
    buffer_load_dwordx4 v2, s[8:11], s57 offen sc1 lds
    s_add_u32 m0, s56, 12288
    s_add_u32 s57, s57, 8192
    buffer_load_dwordx4 v2, s[8:11], s58 offen sc1 lds
    s_cmp_ge_u32 s35, 2
    s_cbranch_scc1 p3w_55
    s_add_u32 m0, s56, 16384
    s_nop 0
    buffer_load_dwordx4 v2, s[8:11], s57 offen sc1 lds
p3w_55:
    s_lshl_b32 s56, s35, 10
    s_add_u32 s56, s56, 116736
    s_cmp_le_u32 s100, 1
    s_cselect_b32 s58, 102400, 0
    s_add_u32 s57, s95, 10240
    s_sub_u32 s57, s57, s58
    s_add_u32 m0, s56, 8192
    s_add_u32 s58, s57, 4096
    buffer_load_dwordx4 v2, s[8:11], s57 offen sc1 lds
    s_add_u32 m0, s56, 12288
    s_add_u32 s57, s57, 8192
    buffer_load_dwordx4 v2, s[8:11], s58 offen sc1 lds
    s_cmp_ge_u32 s35, 2
    s_cbranch_scc1 p3w_56
    s_add_u32 m0, s56, 16384
    s_nop 0
    buffer_load_dwordx4 v2, s[8:11], s57 offen sc1 lds
p3w_56:
    s_lshl_b32 s56, s35, 10
    s_add_u32 s56, s56, 135168
    s_cmp_le_u32 s100, 2
    s_cselect_b32 s58, 102400, 0
    s_add_u32 s57, s95, 20480
    s_sub_u32 s57, s57, s58
    s_add_u32 m0, s56, 8192
    s_add_u32 s58, s57, 4096
    buffer_load_dwordx4 v2, s[8:11], s57 offen sc1 lds
    s_add_u32 m0, s56, 12288
    s_add_u32 s57, s57, 8192
    buffer_load_dwordx4 v2, s[8:11], s58 offen sc1 lds
    s_cmp_ge_u32 s35, 2
    s_cbranch_scc1 p3w_57
    s_add_u32 m0, s56, 16384
    s_nop 0
    buffer_load_dwordx4 v2, s[8:11], s57 offen sc1 lds
p3w_57:
    s_branch concat_heads__linear_kernel_hedgehog__mha_block__prompt_kernel_rt3
concat_heads__linear_kernel_hedgehog__mha_block__prompt_kernel_h71:
    s_lshl_b32 s55, s33, 8
    s_add_u32 s55, s55, 13762560
    buffer_load_dword v248, v191, s[8:11], s55 offen sc1
    s_branch concat_heads__linear_kernel_hedgehog__mha_block__prompt_kernel_rt1
concat_heads__linear_kernel_hedgehog__mha_block__prompt_kernel_h73:
    s_waitcnt vmcnt(0)
    s_lshl_b32 s55, s33, 8
    s_add_u32 s55, s55, 13762560
    v_cmp_eq_u32 vcc, 1, v248
    s_cmp_eq_u64 vcc, -1
    s_cbranch_scc1 fc_58
    buffer_load_dword v248, v191, s[8:11], s55 offen sc1
    s_waitcnt vmcnt(0)
    v_cmp_eq_u32 vcc, 1, v248
    s_cmp_eq_u64 vcc, -1
    s_cbranch_scc1 pw_59_ok
    s_mov_b32 s59, 0
pw_59:
    s_sleep 8
    buffer_load_dword v248, v191, s[8:11], s55 offen sc1
    s_waitcnt vmcnt(0)
    v_cmp_eq_u32 vcc, 1, v248
    s_cmp_eq_u64 vcc, -1
    s_cbranch_scc1 pw_59_ok
    s_add_u32 s59, s59, 1
    s_cmp_lt_u32 s59, 50000
    s_cbranch_scc1 pw_59
pw_59_ok:
fc_58:
    s_lshl_b32 s56, s35, 10
    s_add_u32 s56, s56, 98304
    s_cmp_le_u32 s100, 0
    s_cselect_b32 s58, 81920, 0
    s_add_u32 s57, s94, 0
    s_sub_u32 s57, s57, s58
    s_mov_b32 m0, s56
    s_add_u32 s58, s57, 4096
    buffer_load_dwordx4 v2, s[8:11], s57 offen sc1 lds
    s_add_u32 m0, s56, 4096
    s_nop 0
    buffer_load_dwordx4 v2, s[8:11], s58 offen sc1 lds
    s_lshl_b32 s56, s35, 10
    s_add_u32 s56, s56, 116736
    s_cmp_le_u32 s100, 1
    s_cselect_b32 s58, 81920, 0
    s_add_u32 s57, s94, 8192
    s_sub_u32 s57, s57, s58
    s_mov_b32 m0, s56
    s_add_u32 s58, s57, 4096
    buffer_load_dwordx4 v2, s[8:11], s57 offen sc1 lds
    s_add_u32 m0, s56, 4096
    s_nop 0
    buffer_load_dwordx4 v2, s[8:11], s58 offen sc1 lds
    s_lshl_b32 s56, s35, 10
    s_add_u32 s56, s56, 135168
    s_cmp_le_u32 s100, 2
    s_cselect_b32 s58, 81920, 0
    s_add_u32 s57, s94, 16384
    s_sub_u32 s57, s57, s58
    s_mov_b32 m0, s56
    s_add_u32 s58, s57, 4096
    buffer_load_dwordx4 v2, s[8:11], s57 offen sc1 lds
    s_add_u32 m0, s56, 4096
    s_nop 0
    buffer_load_dwordx4 v2, s[8:11], s58 offen sc1 lds
    s_branch concat_heads__linear_kernel_hedgehog__mha_block__prompt_kernel_rt3
concat_heads__linear_kernel_hedgehog__mha_block__prompt_kernel_h23:
    s_waitcnt vmcnt(0)
    v_mfma_f32_32x32x16_bf16 v[192:207], v[164:167], v[148:151], 0
    v_mfma_f32_32x32x16_bf16 v[218:233], v[164:167], v[180:183], 0
    v_mfma_f32_32x32x8_bf16 v[192:207], v[168:169], v[152:153], v[192:207]
    v_mfma_f32_32x32x8_bf16 v[218:233], v[168:169], v[154:155], v[218:233]
    s_nop 10
    v_exp_f32 v208, -v192
    v_exp_f32 v234, -v218
    v_exp_f32 v192, v192
    v_exp_f32 v218, v218
    v_exp_f32 v209, -v193
    v_exp_f32 v235, -v219
    v_exp_f32 v193, v193
    v_exp_f32 v219, v219
    v_exp_f32 v210, -v194
    v_exp_f32 v236, -v220
    v_exp_f32 v194, v194
    v_exp_f32 v220, v220
    v_exp_f32 v211, -v195
    v_exp_f32 v237, -v221
    v_exp_f32 v195, v195
    v_exp_f32 v221, v221
    v_exp_f32 v212, -v196
    v_exp_f32 v238, -v222
    v_exp_f32 v196, v196
    v_exp_f32 v222, v222
    v_exp_f32 v213, -v197
    v_exp_f32 v239, -v223
    v_exp_f32 v197, v197
    v_exp_f32 v223, v223
    v_exp_f32 v214, -v198
    v_exp_f32 v240, -v224
    v_exp_f32 v198, v198
    v_exp_f32 v224, v224
    v_exp_f32 v215, -v199
    v_exp_f32 v241, -v225
    v_exp_f32 v199, v199
    v_exp_f32 v225, v225
    v_exp_f32 v216, -v200
    v_exp_f32 v242, -v226
    v_exp_f32 v200, v200
    v_exp_f32 v226, v226
    v_exp_f32 v217, -v201
    v_exp_f32 v243, -v227
    v_exp_f32 v201, v201
    v_exp_f32 v227, v227
    v_add_f32 v202, v192, v193
    v_add_f32 v228, v218, v219
    v_add_f32 v203, v208, v209
    v_add_f32 v229, v234, v235
    v_add_f32 v202, v202, v194
    v_add_f32 v228, v228, v220
    v_add_f32 v203, v203, v210
    v_add_f32 v229, v229, v236
    v_add_f32 v202, v202, v195
    v_add_f32 v228, v228, v221
    v_add_f32 v203, v203, v211
    v_add_f32 v229, v229, v237
    v_add_f32 v202, v202, v196
    v_add_f32 v228, v228, v222
    v_add_f32 v203, v203, v212
    v_add_f32 v229, v229, v238
    v_add_f32 v202, v202, v197
    v_add_f32 v228, v228, v223
    v_add_f32 v203, v203, v213
    v_add_f32 v229, v229, v239
    v_add_f32 v202, v202, v198
    v_add_f32 v228, v228, v224
    v_add_f32 v203, v203, v214
    v_add_f32 v229, v229, v240
    v_add_f32 v202, v202, v199
    v_add_f32 v228, v228, v225
    v_add_f32 v203, v203, v215
    v_add_f32 v229, v229, v241
    v_add_f32 v202, v202, v200
    v_add_f32 v228, v228, v226
    v_add_f32 v203, v203, v216
    v_add_f32 v229, v229, v242
    v_add_f32 v202, v202, v201
    v_add_f32 v228, v228, v227
    v_add_f32 v203, v203, v217
    v_add_f32 v229, v229, v243
    v_mov_b32 v204, v202
    v_mov_b32 v230, v228
    v_mov_b32 v205, v203
    v_mov_b32 v231, v229
    v_permlane32_swap_b32 v202, v204
    v_permlane32_swap_b32 v228, v230
    v_permlane32_swap_b32 v203, v205
    v_permlane32_swap_b32 v229, v231
    v_add_f32 v202, v202, v204
    v_add_f32 v228, v228, v230
    v_add_f32 v203, v203, v205
    v_add_f32 v229, v229, v231
    v_max_f32 v204, v202, v203
    v_max_f32 v230, v228, v229
    v_min_f32 v205, v202, v203
    v_min_f32 v231, v228, v229
    v_rcp_f32 v202, v202
    v_rcp_f32 v228, v228
    v_rcp_f32 v203, v203
    v_rcp_f32 v229, v229
    v_mul_f32 v192, v192, v202
    v_mul_f32 v218, v218, v228
    v_mul_f32 v208, v208, v203
    v_mul_f32 v234, v234, v229
    v_mul_f32 v193, v193, v202
    v_mul_f32 v219, v219, v228
    v_mul_f32 v209, v209, v203
    v_mul_f32 v235, v235, v229
    v_mul_f32 v194, v194, v202
    v_mul_f32 v220, v220, v228
    v_mul_f32 v210, v210, v203
    v_mul_f32 v236, v236, v229
    v_mul_f32 v195, v195, v202
    v_mul_f32 v221, v221, v228
    v_mul_f32 v211, v211, v203
    v_mul_f32 v237, v237, v229
    v_mul_f32 v196, v196, v202
    v_mul_f32 v222, v222, v228
    v_mul_f32 v212, v212, v203
    v_mul_f32 v238, v238, v229
    v_mul_f32 v197, v197, v202
    v_mul_f32 v223, v223, v228
    v_mul_f32 v213, v213, v203
    v_mul_f32 v239, v239, v229
    v_mul_f32 v198, v198, v202
    v_mul_f32 v224, v224, v228
    v_mul_f32 v214, v214, v203
    v_mul_f32 v240, v240, v229
    v_mul_f32 v199, v199, v202
    v_mul_f32 v225, v225, v228
    v_mul_f32 v215, v215, v203
    v_mul_f32 v241, v241, v229
    v_mul_f32 v200, v200, v202
    v_mul_f32 v226, v226, v228
    v_mul_f32 v216, v216, v203
    v_mul_f32 v242, v242, v229
    v_mul_f32 v201, v201, v202
    v_mul_f32 v227, v227, v228
    v_mul_f32 v217, v217, v203
    v_mul_f32 v243, v243, v229
    v_cvt_pk_bf16_f32 v244, v192, v193
    v_cvt_pk_bf16_f32 v136, v218, v219
    v_cvt_pk_bf16_f32 v250, v208, v209
    v_cvt_pk_bf16_f32 v142, v234, v235
    v_cvt_pk_bf16_f32 v245, v194, v195
    v_cvt_pk_bf16_f32 v137, v220, v221
    v_cvt_pk_bf16_f32 v251, v210, v211
    v_cvt_pk_bf16_f32 v143, v236, v237
    v_cvt_pk_bf16_f32 v246, v196, v197
    v_cvt_pk_bf16_f32 v138, v222, v223
    v_cvt_pk_bf16_f32 v252, v212, v213
    v_cvt_pk_bf16_f32 v144, v238, v239
    v_cvt_pk_bf16_f32 v247, v198, v199
    v_cvt_pk_bf16_f32 v139, v224, v225
    v_cvt_pk_bf16_f32 v253, v214, v215
    v_cvt_pk_bf16_f32 v145, v240, v241
    v_cvt_pk_bf16_f32 v248, v200, v201
    v_cvt_pk_bf16_f32 v140, v226, v227
    v_cvt_pk_bf16_f32 v254, v216, v217
    v_cvt_pk_bf16_f32 v146, v242, v243
    v_mov_b32 v249, 0
    v_mov_b32 v141, 0
    v_mov_b32 v255, 0
    v_mov_b32 v147, 0
    v_max_f32 v204, v204, v230
    v_min_f32 v205, v205, v231
    v_mov_b32 v185, 0x5d800000
    v_mov_b32 v186, 0x21800000
    v_cmp_le_f32 vcc, v204, v185
    v_cmp_ge_f32 s[58:59], v205, v186
    s_and_b64 vcc, vcc, s[58:59]
    s_cmp_eq_u64 vcc, -1
    s_cbranch_scc1 pf_60
    v_mfma_f32_32x32x16_bf16 v[192:207], v[164:167], v[148:151], 0
    v_mfma_f32_32x32x16_bf16 v[218:233], v[164:167], v[180:183], 0
    v_mfma_f32_32x32x8_bf16 v[192:207], v[168:169], v[152:153], v[192:207]
    v_mfma_f32_32x32x8_bf16 v[218:233], v[168:169], v[154:155], v[218:233]
    s_nop 10
    v_max3_f32 v202, v192, v193, v194
    v_max3_f32 v228, v218, v219, v220
    v_min3_f32 v203, v192, v193, v194
    v_min3_f32 v229, v218, v219, v220
    v_max3_f32 v202, v202, v195, v196
    v_max3_f32 v228, v228, v221, v222
    v_min3_f32 v203, v203, v195, v196
    v_min3_f32 v229, v229, v221, v222
    v_max3_f32 v202, v202, v197, v198
    v_max3_f32 v228, v228, v223, v224
    v_min3_f32 v203, v203, v197, v198
    v_min3_f32 v229, v229, v223, v224
    v_max3_f32 v202, v202, v199, v200
    v_max3_f32 v228, v228, v225, v226
    v_min3_f32 v203, v203, v199, v200
    v_min3_f32 v229, v229, v225, v226
    v_max_f32 v202, v202, v201
    v_max_f32 v228, v228, v227
    v_min_f32 v203, v203, v201
    v_min_f32 v229, v229, v227
    v_mov_b32 v204, v202
    v_mov_b32 v230, v228
    v_mov_b32 v205, v203
    v_mov_b32 v231, v229
    v_permlane32_swap_b32 v202, v204
    v_permlane32_swap_b32 v228, v230
    v_permlane32_swap_b32 v203, v205
    v_permlane32_swap_b32 v229, v231
    v_max_f32 v202, v202, v204
    v_max_f32 v228, v228, v230
    v_min_f32 v203, v203, v205
    v_min_f32 v229, v229, v231
    v_mul_f32 v202, s41, v202
    v_mul_f32 v228, s41, v228
    v_mul_f32 v203, s40, v203
    v_mul_f32 v229, s40, v229
    v_fma_f32 v208, v192, s41, v203
    v_fma_f32 v234, v218, s41, v229
    v_fma_f32 v192, v192, s40, v202
    v_fma_f32 v218, v218, s40, v228
    v_fma_f32 v209, v193, s41, v203
    v_fma_f32 v235, v219, s41, v229
    v_fma_f32 v193, v193, s40, v202
    v_fma_f32 v219, v219, s40, v228
    v_fma_f32 v210, v194, s41, v203
    v_fma_f32 v236, v220, s41, v229
    v_fma_f32 v194, v194, s40, v202
    v_fma_f32 v220, v220, s40, v228
    v_fma_f32 v211, v195, s41, v203
    v_fma_f32 v237, v221, s41, v229
    v_fma_f32 v195, v195, s40, v202
    v_fma_f32 v221, v221, s40, v228
    v_fma_f32 v212, v196, s41, v203
    v_fma_f32 v238, v222, s41, v229
    v_fma_f32 v196, v196, s40, v202
    v_fma_f32 v222, v222, s40, v228
    v_fma_f32 v213, v197, s41, v203
    v_fma_f32 v239, v223, s41, v229
    v_fma_f32 v197, v197, s40, v202
    v_fma_f32 v223, v223, s40, v228
    v_fma_f32 v214, v198, s41, v203
    v_fma_f32 v240, v224, s41, v229
    v_fma_f32 v198, v198, s40, v202
    v_fma_f32 v224, v224, s40, v228
    v_fma_f32 v215, v199, s41, v203
    v_fma_f32 v241, v225, s41, v229
    v_fma_f32 v199, v199, s40, v202
    v_fma_f32 v225, v225, s40, v228
    v_fma_f32 v216, v200, s41, v203
    v_fma_f32 v242, v226, s41, v229
    v_fma_f32 v200, v200, s40, v202
    v_fma_f32 v226, v226, s40, v228
    v_fma_f32 v217, v201, s41, v203
    v_fma_f32 v243, v227, s41, v229
    v_fma_f32 v201, v201, s40, v202
    v_fma_f32 v227, v227, s40, v228
    v_exp_f32 v208, v208
    v_exp_f32 v234, v234
    v_exp_f32 v192, v192
    v_exp_f32 v218, v218
    v_exp_f32 v209, v209
    v_exp_f32 v235, v235
    v_exp_f32 v193, v193
    v_exp_f32 v219, v219
    v_exp_f32 v210, v210
    v_exp_f32 v236, v236
    v_exp_f32 v194, v194
    v_exp_f32 v220, v220
    v_exp_f32 v211, v211
    v_exp_f32 v237, v237
    v_exp_f32 v195, v195
    v_exp_f32 v221, v221
    v_exp_f32 v212, v212
    v_exp_f32 v238, v238
    v_exp_f32 v196, v196
    v_exp_f32 v222, v222
    v_exp_f32 v213, v213
    v_exp_f32 v239, v239
    v_exp_f32 v197, v197
    v_exp_f32 v223, v223
    v_exp_f32 v214, v214
    v_exp_f32 v240, v240
    v_exp_f32 v198, v198
    v_exp_f32 v224, v224
    v_exp_f32 v215, v215
    v_exp_f32 v241, v241
    v_exp_f32 v199, v199
    v_exp_f32 v225, v225
    v_exp_f32 v216, v216
    v_exp_f32 v242, v242
    v_exp_f32 v200, v200
    v_exp_f32 v226, v226
    v_exp_f32 v217, v217
    v_exp_f32 v243, v243
    v_exp_f32 v201, v201
    v_exp_f32 v227, v227
    v_add_f32 v202, v192, v193
    v_add_f32 v228, v218, v219
    v_add_f32 v203, v208, v209
    v_add_f32 v229, v234, v235
    v_add_f32 v202, v202, v194
    v_add_f32 v228, v228, v220
    v_add_f32 v203, v203, v210
    v_add_f32 v229, v229, v236
    v_add_f32 v202, v202, v195
    v_add_f32 v228, v228, v221
    v_add_f32 v203, v203, v211
    v_add_f32 v229, v229, v237
    v_add_f32 v202, v202, v196
    v_add_f32 v228, v228, v222
    v_add_f32 v203, v203, v212
    v_add_f32 v229, v229, v238
    v_add_f32 v202, v202, v197
    v_add_f32 v228, v228, v223
    v_add_f32 v203, v203, v213
    v_add_f32 v229, v229, v239
    v_add_f32 v202, v202, v198
    v_add_f32 v228, v228, v224
    v_add_f32 v203, v203, v214
    v_add_f32 v229, v229, v240
    v_add_f32 v202, v202, v199
    v_add_f32 v228, v228, v225
    v_add_f32 v203, v203, v215
    v_add_f32 v229, v229, v241
    v_add_f32 v202, v202, v200
    v_add_f32 v228, v228, v226
    v_add_f32 v203, v203, v216
    v_add_f32 v229, v229, v242
    v_add_f32 v202, v202, v201
    v_add_f32 v228, v228, v227
    v_add_f32 v203, v203, v217
    v_add_f32 v229, v229, v243
    v_mov_b32 v204, v202
    v_mov_b32 v230, v228
    v_mov_b32 v205, v203
    v_mov_b32 v231, v229
    v_permlane32_swap_b32 v202, v204
    v_permlane32_swap_b32 v228, v230
    v_permlane32_swap_b32 v203, v205
    v_permlane32_swap_b32 v229, v231
    v_add_f32 v202, v202, v204
    v_add_f32 v228, v228, v230
    v_add_f32 v203, v203, v205
    v_add_f32 v229, v229, v231
    v_rcp_f32 v202, v202
    v_rcp_f32 v228, v228
    v_rcp_f32 v203, v203
    v_rcp_f32 v229, v229
    v_mul_f32 v192, v192, v202
    v_mul_f32 v218, v218, v228
    v_mul_f32 v208, v208, v203
    v_mul_f32 v234, v234, v229
    v_mul_f32 v193, v193, v202
    v_mul_f32 v219, v219, v228
    v_mul_f32 v209, v209, v203
    v_mul_f32 v235, v235, v229
    v_mul_f32 v194, v194, v202
    v_mul_f32 v220, v220, v228
    v_mul_f32 v210, v210, v203
    v_mul_f32 v236, v236, v229
    v_mul_f32 v195, v195, v202
    v_mul_f32 v221, v221, v228
    v_mul_f32 v211, v211, v203
    v_mul_f32 v237, v237, v229
    v_mul_f32 v196, v196, v202
    v_mul_f32 v222, v222, v228
    v_mul_f32 v212, v212, v203
    v_mul_f32 v238, v238, v229
    v_mul_f32 v197, v197, v202
    v_mul_f32 v223, v223, v228
    v_mul_f32 v213, v213, v203
    v_mul_f32 v239, v239, v229
    v_mul_f32 v198, v198, v202
    v_mul_f32 v224, v224, v228
    v_mul_f32 v214, v214, v203
    v_mul_f32 v240, v240, v229
    v_mul_f32 v199, v199, v202
    v_mul_f32 v225, v225, v228
    v_mul_f32 v215, v215, v203
    v_mul_f32 v241, v241, v229
    v_mul_f32 v200, v200, v202
    v_mul_f32 v226, v226, v228
    v_mul_f32 v216, v216, v203
    v_mul_f32 v242, v242, v229
    v_mul_f32 v201, v201, v202
    v_mul_f32 v227, v227, v228
    v_mul_f32 v217, v217, v203
    v_mul_f32 v243, v243, v229
    v_cvt_pk_bf16_f32 v244, v192, v193
    v_cvt_pk_bf16_f32 v136, v218, v219
    v_cvt_pk_bf16_f32 v250, v208, v209
    v_cvt_pk_bf16_f32 v142, v234, v235
    v_cvt_pk_bf16_f32 v245, v194, v195
    v_cvt_pk_bf16_f32 v137, v220, v221
    v_cvt_pk_bf16_f32 v251, v210, v211
    v_cvt_pk_bf16_f32 v143, v236, v237
    v_cvt_pk_bf16_f32 v246, v196, v197
    v_cvt_pk_bf16_f32 v138, v222, v223
    v_cvt_pk_bf16_f32 v252, v212, v213
    v_cvt_pk_bf16_f32 v144, v238, v239
    v_cvt_pk_bf16_f32 v247, v198, v199
    v_cvt_pk_bf16_f32 v139, v224, v225
    v_cvt_pk_bf16_f32 v253, v214, v215
    v_cvt_pk_bf16_f32 v145, v240, v241
    v_cvt_pk_bf16_f32 v248, v200, v201
    v_cvt_pk_bf16_f32 v140, v226, v227
    v_cvt_pk_bf16_f32 v254, v216, v217
    v_cvt_pk_bf16_f32 v146, v242, v243
    v_mov_b32 v249, 0
    v_mov_b32 v141, 0
    v_mov_b32 v255, 0
    v_mov_b32 v147, 0
pf_60:
    s_mul_i32 s55, s32, 5120
    s_add_u32 s55, s55, 98304
    v_add_u32 v184, s55, v2
    v_mfma_f32_32x32x16_bf16 v[192:207], v[244:247], v[172:175], 0
    v_mfma_f32_32x32x16_bf16 v[208:223], v[250:253], v[172:175], 0
    v_mfma_f32_32x32x8_bf16 v[192:207], v[248:249], v[176:177], v[192:207]
    v_mfma_f32_32x32x8_bf16 v[208:223], v[254:255], v[176:177], v[208:223]
    s_nop 10
    v_cvt_pk_bf16_f32 v224, v192, v193
    v_cvt_pk_bf16_f32 v225, v194, v195
    v_cvt_pk_bf16_f32 v226, v196, v197
    v_cvt_pk_bf16_f32 v227, v198, v199
    v_cvt_pk_bf16_f32 v228, v200, v201
    v_cvt_pk_bf16_f32 v229, v202, v203
    v_cvt_pk_bf16_f32 v230, v204, v205
    v_cvt_pk_bf16_f32 v231, v206, v207
    v_cvt_pk_bf16_f32 v232, v208, v209
    v_cvt_pk_bf16_f32 v233, v210, v211
    v_cvt_pk_bf16_f32 v234, v212, v213
    v_cvt_pk_bf16_f32 v235, v214, v215
    v_cvt_pk_bf16_f32 v236, v216, v217
    v_cvt_pk_bf16_f32 v237, v218, v219
    v_cvt_pk_bf16_f32 v238, v220, v221
    v_cvt_pk_bf16_f32 v239, v222, v223
    v_mfma_f32_32x32x16_bf16 v[192:207], v[224:227], v[156:159], 0
    v_mfma_f32_32x32x16_bf16 v[208:223], v[232:235], v[156:159], 0
    v_mfma_f32_32x32x16_bf16 v[192:207], v[228:231], v[160:163], v[192:207]
    v_mfma_f32_32x32x16_bf16 v[208:223], v[236:239], v[160:163], v[208:223]
    s_nop 10
    ds_write_b128 v184, v[192:195]
    ds_write_b128 v184, v[196:199] offset:1024
    v_mov_b32 v202, v216
    v_mov_b32 v203, v217
    ds_write_b128 v184, v[208:211] offset:3072
    ds_write_b128 v184, v[212:215] offset:4096
    ds_write_b128 v184, v[200:203] offset:2048
    s_branch concat_heads__linear_kernel_hedgehog__mha_block__prompt_kernel_rt3
concat_heads__linear_kernel_hedgehog__mha_block__prompt_kernel_h13:
    s_cmp_eq_u32 s32, 0
    s_cbranch_scc0 concat_heads__linear_kernel_hedgehog__mha_block__prompt_kernel_rt3
    s_waitcnt vmcnt(3)
    s_mov_b32 s55, 13783040
    v_and_b32 v248, v248, v249
    v_and_b32 v250, v250, v251
    v_and_b32 v248, v248, v250
    v_cmp_eq_u32 vcc, 1, v248
    s_and_b32 s58, vcc_lo, 0xffffff
    s_cmp_eq_u32 s58, 0xffffff
    s_cbranch_scc1 fc_61
    s_mov_b32 exec_lo, 0xffffff
    s_mov_b32 exec_hi, 0
    buffer_load_dwordx4 v[248:251], v188, s[8:11], s55 offen sc1
    s_waitcnt vmcnt(0)
    v_and_b32 v248, v248, v249
    v_and_b32 v250, v250, v251
    v_and_b32 v248, v248, v250
    v_cmp_eq_u32 vcc, 1, v248
    s_and_b32 s58, vcc_lo, 0xffffff
    s_cmp_eq_u32 s58, 0xffffff
    s_cbranch_scc1 pw_62_ok
    s_mov_b32 s59, 0
pw_62:
    s_sleep 8
    buffer_load_dwordx4 v[248:251], v188, s[8:11], s55 offen sc1
    s_waitcnt vmcnt(0)
    v_and_b32 v248, v248, v249
    v_and_b32 v250, v250, v251
    v_and_b32 v248, v248, v250
    v_cmp_eq_u32 vcc, 1, v248
    s_and_b32 s58, vcc_lo, 0xffffff
    s_cmp_eq_u32 s58, 0xffffff
    s_cbranch_scc1 pw_62_ok
    s_add_u32 s59, s59, 1
    s_cmp_lt_u32 s59, 50000
    s_cbranch_scc1 pw_62
pw_62_ok:
    s_mov_b64 exec, -1
fc_61:
    s_branch concat_heads__linear_kernel_hedgehog__mha_block__prompt_kernel_rt3
concat_heads__linear_kernel_hedgehog__mha_block__prompt_kernel_h33:
    s_cmp_ge_u32 s32, 5
    s_cbranch_scc1 concat_heads__linear_kernel_hedgehog__mha_block__prompt_kernel_rt3
    s_waitcnt vmcnt(0)
    s_lshl_b32 s55, s33, 8
    s_lshl_b32 s56, s32, 5
    s_add_u32 s55, s55, s56
    s_lshl_b32 s56, s34, 2
    s_add_u32 s55, s55, s56
    s_add_u32 s55, s55, 13787136
    v_mov_b32 v184, 0
    v_mov_b32 v185, 1
    s_mov_b64 exec, 1
    buffer_store_dword v185, v184, s[8:11], s55 offen sc1
    s_mov_b64 exec, -1
    s_branch concat_heads__linear_kernel_hedgehog__mha_block__prompt_kernel_rt3
concat_heads__linear_kernel_hedgehog__mha_block__prompt_kernel_h43:
    s_cmp_ge_u32 s32, 5
    s_cbranch_scc1 concat_heads__linear_kernel_hedgehog__mha_block__prompt_kernel_rt3
    s_lshl_b32 s55, s33, 8
    s_lshl_b32 s56, s32, 5
    s_add_u32 s55, s55, s56
    s_add_u32 s55, s55, 13787136
    s_waitcnt vmcnt(3)
    v_cmp_eq_u32 vcc, 1, v248
    s_and_b32 s58, vcc_lo, 0xff
    s_cmp_eq_u32 s58, 0xff
    s_cbranch_scc1 fc_63
    buffer_load_dword v248, v188, s[8:11], s55 offen sc1
    s_waitcnt vmcnt(0)
    v_cmp_eq_u32 vcc, 1, v248
    s_and_b32 s58, vcc_lo, 0xff
    s_cmp_eq_u32 s58, 0xff
    s_cbranch_scc1 pw_64_ok
    s_mov_b32 s59, 0
pw_64:
    s_sleep 8
    buffer_load_dword v248, v188, s[8:11], s55 offen sc1
    s_waitcnt vmcnt(0)
    v_cmp_eq_u32 vcc, 1, v248
    s_and_b32 s58, vcc_lo, 0xff
    s_cmp_eq_u32 s58, 0xff
    s_cbranch_scc1 pw_64_ok
    s_add_u32 s59, s59, 1
    s_cmp_lt_u32 s59, 50000
    s_cbranch_scc1 pw_64
pw_64_ok:
fc_63:
    s_mul_i32 s55, s33, 40960
    s_lshl_b32 s56, s32, 10
    s_add_u32 s55, s55, s56
    s_add_u32 s55, s55, 11534336
    s_add_u32 s56, s55, 0
    buffer_load_dwordx4 v[148:151], v2, s[8:11], s56 offen sc1
    s_add_u32 s56, s55, 5120
    buffer_load_dwordx4 v[152:155], v2, s[8:11], s56 offen sc1
    s_add_u32 s56, s55, 10240
    buffer_load_dwordx4 v[156:159], v2, s[8:11], s56 offen sc1
    s_add_u32 s56, s55, 15360
    buffer_load_dwordx4 v[160:163], v2, s[8:11], s56 offen sc1
    s_add_u32 s56, s55, 20480
    buffer_load_dwordx4 v[164:167], v2, s[8:11], s56 offen sc1
    s_add_u32 s56, s55, 25600
    buffer_load_dwordx4 v[168:171], v2, s[8:11], s56 offen sc1
    s_add_u32 s56, s55, 30720
    buffer_load_dwordx4 v[172:175], v2, s[8:11], s56 offen sc1
    s_add_u32 s56, s55, 35840
    buffer_load_dwordx4 v[176:179], v2, s[8:11], s56 offen sc1
    s_branch concat_heads__linear_kernel_hedgehog__mha_block__prompt_kernel_rt3
concat_heads__linear_kernel_hedgehog__mha_block__prompt_kernel_h63:
    s_waitcnt vmcnt(0)
    s_lshl_b32 s56, s34, 2
    s_add_u32 s56, s56, s35
    s_lshl_b32 s56, s56, 8
    s_lshl_b32 s57, s33, 3
    s_add_u32 s56, s56, s57
    s_lshl_b32 s57, s36, 2
    s_add_u32 s56, s56, s57
    s_add_u32 s56, s56, 13762560
    v_mov_b32 v184, 0
    v_mov_b32 v185, 1
    s_mov_b64 exec, 1
    buffer_store_dword v185, v184, s[8:11], s56 offen sc1
    s_mov_b64 exec, -1
    s_branch concat_heads__linear_kernel_hedgehog__mha_block__prompt_kernel_rt3
concat_heads__linear_kernel_hedgehog__mha_block__prompt_kernel_tail:
    v_mfma_f32_32x32x16_bf16 v[80:95], v[120:123], v[56:59], v[80:95]
    v_mfma_f32_32x32x16_bf16 v[80:95], v[124:127], v[60:63], v[80:95]
    s_mul_i32 s55, s32, 3072
    s_add_u32 s55, s55, 0
    v_add_u32 v184, s55, v2
    s_cmp_eq_u32 s36, 0
    s_cbranch_scc1 concat_heads__linear_kernel_hedgehog__mha_block__prompt_kernel_x0
    ds_write_b128 v184, v[64:67]
    ds_write_b128 v184, v[68:71] offset:1024
    ds_write_b128 v184, v[72:75] offset:2048
    s_nop 3
    v_mov_b32 v64, v80
    v_mov_b32 v65, v81
    v_mov_b32 v66, v82
    v_mov_b32 v67, v83
    v_mov_b32 v68, v84
    v_mov_b32 v69, v85
    v_mov_b32 v70, v86
    v_mov_b32 v71, v87
    v_mov_b32 v72, v88
    v_mov_b32 v73, v89
    v_mov_b32 v74, v90
    v_mov_b32 v75, v91
    s_branch concat_heads__linear_kernel_hedgehog__mha_block__prompt_kernel_x1
concat_heads__linear_kernel_hedgehog__mha_block__prompt_kernel_x0:
    s_nop 6
    ds_write_b128 v184, v[80:83]
    ds_write_b128 v184, v[84:87] offset:1024
    ds_write_b128 v184, v[88:91] offset:2048
concat_heads__linear_kernel_hedgehog__mha_block__prompt_kernel_x1:
    s_waitcnt lgkmcnt(0)
    s_barrier
    s_xor_b32 s55, s32, 4
    s_mul_i32 s55, s55, 3072
    s_add_u32 s55, s55, 0
    v_add_u32 v184, s55, v2
    ds_read_b128 v[16:19], v184
    ds_read_b128 v[20:23], v184 offset:1024
    ds_read_b128 v[24:27], v184 offset:2048
    s_mul_i32 s55, s33, 20
    v_lshlrev_b32 v186, 2, v131
    v_add_u32 v186, s55, v186
    v_and_b32 v187, 7, v186
    v_lshlrev_b32 v187, 1, v187
    v_lshrrev_b32 v186, 3, v186
    v_lshlrev_b32 v186, 10, v186
    v_add_u32 v186, v186, v187
    s_lshl_b32 s55, s36, 5
    v_add_u32 v187, s55, v3
    v_lshlrev_b32 v187, 4, v187
    v_add_u32 v186, v186, v187
    s_lshl_b32 s55, s34, 2
    s_add_u32 s55, s55, s35
    s_mul_i32 s55, s55, 81920
    s_add_u32 s55, s55, 8388608
    s_add_u32 s55, s55, 16777216
    s_waitcnt lgkmcnt(0)
    v_add_f32 v64, v64, v16
    v_add_f32 v65, v65, v17
    v_add_f32 v66, v66, v18
    v_add_f32 v67, v67, v19
    v_add_f32 v68, v68, v20
    v_add_f32 v69, v69, v21
    v_add_f32 v70, v70, v22
    v_add_f32 v71, v71, v23
    v_add_f32 v72, v72, v24
    v_add_f32 v73, v73, v25
    v_add_f32 v74, v74, v26
    v_add_f32 v75, v75, v27
    v_mov_b32 v16, v72
    v_mov_b32 v17, v72
    s_nop 1
    v_permlane32_swap_b32 v16, v17
    v_max3_f32 v18, |v64|, |v65|, |v66|
    v_max3_f32 v18, v18, |v67|, |v68|
    v_max3_f32 v18, v18, |v69|, |v70|
    v_max3_f32 v18, v18, |v71|, |v72|
    v_max3_f32 v18, v18, |v73|, |v74|
    v_max_f32 v18, v18, |v75|
    v_mov_b32 v19, 0x21800000
    v_mov_b32 v20, 0x5d800000
    v_mov_b32 v21, 0x7f000000
    v_cmp_ge_f32 vcc, v17, v19
    v_cmp_le_f32 s[58:59], v17, v20
    s_and_b64 vcc, vcc, s[58:59]
    v_cmp_lt_f32 s[58:59], v18, v21
    s_and_b64 vcc, vcc, s[58:59]
    s_cmp_eq_u64 vcc, -1
    s_cbranch_scc0 concat_heads__linear_kernel_hedgehog__mha_block__prompt_kernel_slow
concat_heads__linear_kernel_hedgehog__mha_block__prompt_kernel_fin:
    v_rcp_f32 v17, v17
    s_nop 0
    v_mul_f32 v64, v64, v17
    v_mul_f32 v65, v65, v17
    v_mul_f32 v66, v66, v17
    v_mul_f32 v67, v67, v17
    v_mul_f32 v68, v68, v17
    v_mul_f32 v69, v69, v17
    v_mul_f32 v70, v70, v17
    v_mul_f32 v71, v71, v17
    v_mul_f32 v72, v72, v17
    v_mul_f32 v73, v73, v17
    v_mul_f32 v74, v74, v17
    v_mul_f32 v75, v75, v17
    v_cvt_pk_bf16_f32 v20, v64, v65
    v_cvt_pk_bf16_f32 v21, v66, v67
    v_cvt_pk_bf16_f32 v22, v68, v69
    v_cvt_pk_bf16_f32 v23, v70, v71
    v_cvt_pk_bf16_f32 v24, v72, v73
    v_cvt_pk_bf16_f32 v25, v74, v75
    buffer_store_dwordx2 v[20:21], v186, s[8:11], s55 offen sc1
    buffer_store_dwordx2 v[22:23], v186, s[8:11], s55 offen offset:1024 sc1
    s_mov_b32 exec_hi, 0
    buffer_store_dwordx2 v[24:25], v186, s[8:11], s55 offen offset:2048 sc1
    s_mov_b64 exec, -1
    s_branch concat_heads__linear_kernel_hedgehog__mha_block__prompt_kernel_p3
concat_heads__linear_kernel_hedgehog__mha_block__prompt_kernel_slow:
    s_cmp_eq_u32 s36, 0
    s_cbranch_scc1 concat_heads__linear_kernel_hedgehog__mha_block__prompt_kernel_sl0
    v_mov_b32 v4, v8
    v_mov_b32 v5, v9
    v_mov_b32 v6, v10
    v_mov_b32 v7, v11
    v_mov_b32 v12, v14
    v_mov_b32 v13, v15
concat_heads__linear_kernel_hedgehog__mha_block__prompt_kernel_sl0:
    v_mov_b32 v64, 0
    v_mov_b32 v65, 0
    v_mov_b32 v66, 0
    v_mov_b32 v67, 0
    v_mov_b32 v68, 0
    v_mov_b32 v69, 0
    v_mov_b32 v70, 0
    v_mov_b32 v71, 0
    v_mov_b32 v72, 0
    v_mov_b32 v73, 0
    v_mov_b32 v74, 0
    v_mov_b32 v75, 0
    v_mov_b32 v76, 0
    v_mov_b32 v77, 0
    v_mov_b32 v78, 0
    v_mov_b32 v79, 0
    v_lshlrev_b32 v42, 15, v131
    v_lshlrev_b32 v43, 4, v3
    v_add_u32 v42, v42, v43
    v_add_u32 v43, s68, v43
    v_mov_b32 v44, 0xff7fffff
    v_mul_u32_u24 v184, 320, v131
    v_lshlrev_b32 v185, 4, v3
    v_add_u32 v184, v184, v185
    s_mov_b32 s57, 0
concat_heads__linear_kernel_hedgehog__mha_block__prompt_kernel_sloop:
    s_lshl_b32 s56, s57, 9
    s_add_u32 s56, s56, 16777216
    s_add_u32 s58, s66, 80
    s_lshl_b32 s58, s58, 15
    s_add_u32 s58, s58, s56
    buffer_load_dwordx4 v[96:99], v42, s[8:11], s58 offen sc1
    s_add_u32 s58, s67, 80
    s_lshl_b32 s58, s58, 15
    s_add_u32 s58, s58, s56
    buffer_load_dwordx2 v[100:101], v43, s[8:11], s58 offen sc1
    s_lshr_b32 s56, s57, 2
    s_mul_i32 s56, s56, 5120
    s_and_b32 s58, s57, 3
    s_mul_i32 s58, s58, 1280
    s_add_u32 s58, s58, s56
    s_add_u32 s58, s58, s53
    s_mov_b64 exec, s[42:43]
    buffer_load_dwordx4 v[104:107], v184, s[8:11], s58 offen sc1
    buffer_load_dwordx4 v[108:111], v184, s[8:11], s58 offen offset:640 sc1
    s_mov_b64 exec, -1
    s_waitcnt vmcnt(0)
    v_mfma_f32_32x32x16_bf16 v[16:31], v[96:99], v[4:7], 0
    v_mfma_f32_32x32x8_bf16 v[16:31], v[100:101], v[12:13], v[16:31]
    s_nop 11
    v_max3_f32 v45, v16, v17, v18
    v_max3_f32 v45, v45, v19, v20
    v_max3_f32 v45, v45, v21, v22
    v_max3_f32 v45, v45, v23, v24
    v_max3_f32 v45, v45, v25, v26
    v_max3_f32 v45, v45, v27, v28
    v_max3_f32 v45, v45, v29, v30
    v_max_f32 v45, v45, v31
    v_mov_b32 v46, v45
    s_nop 1
    v_permlane32_swap_b32 v45, v46
    v_max3_f32 v45, v45, v46, v44
    v_sub_f32 v46, v44, v45
    v_exp_f32 v46, v46
    v_mov_b32 v44, v45
    v_sub_f32 v16, v16, v45
    v_sub_f32 v17, v17, v45
    v_sub_f32 v18, v18, v45
    v_sub_f32 v19, v19, v45
    v_sub_f32 v20, v20, v45
    v_sub_f32 v21, v21, v45
    v_sub_f32 v22, v22, v45
    v_sub_f32 v23, v23, v45
    v_sub_f32 v24, v24, v45
    v_sub_f32 v25, v25, v45
    v_sub_f32 v26, v26, v45
    v_sub_f32 v27, v27, v45
    v_sub_f32 v28, v28, v45
    v_sub_f32 v29, v29, v45
    v_sub_f32 v30, v30, v45
    v_sub_f32 v31, v31, v45
    v_exp_f32 v16, v16
    v_exp_f32 v17, v17
    v_exp_f32 v18, v18
    v_exp_f32 v19, v19
    v_exp_f32 v20, v20
    v_exp_f32 v21, v21
    v_exp_f32 v22, v22
    v_exp_f32 v23, v23
    v_exp_f32 v24, v24
    v_exp_f32 v25, v25
    v_exp_f32 v26, v26
    v_exp_f32 v27, v27
    v_exp_f32 v28, v28
    v_exp_f32 v29, v29
    v_exp_f32 v30, v30
    v_exp_f32 v31, v31
    v_mul_f32 v64, v64, v46
    v_mul_f32 v65, v65, v46
    v_mul_f32 v66, v66, v46
    v_mul_f32 v67, v67, v46
    v_mul_f32 v68, v68, v46
    v_mul_f32 v69, v69, v46
    v_mul_f32 v70, v70, v46
    v_mul_f32 v71, v71, v46
    v_mul_f32 v72, v72, v46
    v_mul_f32 v73, v73, v46
    v_mul_f32 v74, v74, v46
    v_mul_f32 v75, v75, v46
    v_mul_f32 v76, v76, v46
    v_mul_f32 v77, v77, v46
    v_mul_f32 v78, v78, v46
    v_mul_f32 v79, v79, v46
    v_cvt_pk_bf16_f32 v48, v16, v17
    v_cvt_pk_bf16_f32 v49, v18, v19
    v_cvt_pk_bf16_f32 v50, v20, v21
    v_cvt_pk_bf16_f32 v51, v22, v23
    v_cvt_pk_bf16_f32 v52, v24, v25
    v_cvt_pk_bf16_f32 v53, v26, v27
    v_cvt_pk_bf16_f32 v54, v28, v29
    v_cvt_pk_bf16_f32 v55, v30, v31
    v_mfma_f32_32x32x16_bf16 v[64:79], v[104:107], v[48:51], v[64:79]
    s_nop 0
    v_mfma_f32_32x32x16_bf16 v[64:79], v[108:111], v[52:55], v[64:79]
    s_add_u32 s57, s57, 1
    s_cmp_lt_u32 s57, 64
    s_cbranch_scc1 concat_heads__linear_kernel_hedgehog__mha_block__prompt_kernel_sloop
    s_nop 15
    v_mov_b32 v16, v72
    v_mov_b32 v17, v72
    s_nop 1
    v_permlane32_swap_b32 v16, v17
    s_branch concat_heads__linear_kernel_hedgehog__mha_block__prompt_kernel_fin
concat_heads__linear_kernel_hedgehog__mha_block__prompt_kernel_p3:
    s_cmp_eq_u32 s36, 1
    s_cbranch_scc1 concat_heads__linear_kernel_hedgehog__mha_block__prompt_kernel_p3load
    s_load_dwordx2 s[24:25], s[0:1], 56
    v_and_b32 v8, 15, v1
    v_lshrrev_b32 v9, 4, v1
    s_lshr_b32 s44, s35, 1
    s_lshl_b32 s44, s44, 5
    v_add_u32 v10, s44, v8
    v_lshlrev_b32 v10, 4, v10
    v_lshlrev_b32 v11, 10, v9
    v_add_u32 v10, v10, v11
    v_add_u32 v4, 24576, v10
    v_add_u32 v5, 98304, v10
    v_lshlrev_b32 v10, 3, v1
    s_and_b32 s45, s35, 1
    s_lshl_b32 s45, s45, 10
    s_add_u32 s45, s45, 8192
    v_add_u32 v10, s45, v10
    v_add_u32 v6, 24576, v10
    v_add_u32 v7, 98304, v10
    v_add_u32 v10, s44, v8
    v_mul_u32_u24 v10, 160, v10
    v_lshlrev_b32 v11, 3, v9
    s_and_b32 s45, s35, 1
    s_lshl_b32 s45, s45, 6
    s_add_u32 s45, s45, 153600
    v_add3_u32 v10, v10, v11, s45
    s_lshl_b32 s51, s35, 6
    s_add_u32 s51, s51, 0
    v_add_u32 v11, s51, v1
    v_lshlrev_b32 v12, 4, v11
    v_add_u32 v12, 153600, v12
    v_mul_u32_u24 v8, 6554, v11
    v_lshrrev_b32 v8, 16, v8
    v_mul_u32_u24 v9, 10, v8
    v_sub_u32 v9, v11, v9
    v_lshlrev_b32 v9, 4, v9
    v_mul_u32_u24 v8, 2560, v8
    v_add_u32 v140, v8, v9
    s_lshl_b32 s51, s35, 6
    s_add_u32 s51, s51, 256
    v_add_u32 v11, s51, v1
    v_lshlrev_b32 v13, 4, v11
    v_add_u32 v13, 153600, v13
    v_mul_u32_u24 v8, 6554, v11
    v_lshrrev_b32 v8, 16, v8
    v_mul_u32_u24 v9, 10, v8
    v_sub_u32 v9, v11, v9
    v_lshlrev_b32 v9, 4, v9
    v_mul_u32_u24 v8, 2560, v8
    v_add_u32 v141, v8, v9
    s_lshl_b32 s51, s35, 6
    s_add_u32 s51, s51, 512
    v_add_u32 v11, s51, v1
    v_lshlrev_b32 v14, 4, v11
    v_add_u32 v14, 153600, v14
    v_mul_u32_u24 v8, 6554, v11
    v_lshrrev_b32 v8, 16, v8
    v_mul_u32_u24 v9, 10, v8
    v_sub_u32 v9, v11, v9
    v_lshlrev_b32 v9, 4, v9
    v_mul_u32_u24 v8, 2560, v8
    v_add_u32 v142, v8, v9
    s_mul_i32 s50, s33, 163840
    s_mul_i32 s51, s34, 160
    s_add_u32 s50, s50, s51
    s_waitcnt lgkmcnt(0)
    s_mov_b32 s28, s24
    s_and_b32 s29, s25, 0xffff
    s_mov_b32 s30, 0x500000
    s_mov_b32 s31, 0x20000
    s_barrier
    ds_read_b128 v[16:19], v5 offset:0
    ds_read_b128 v[20:23], v5 offset:256
    ds_read_b64_tr_b16 v[24:25], v7 offset:0
    ds_read_b64_tr_b16 v[26:27], v7 offset:2560
    ds_read_b64_tr_b16 v[28:29], v7 offset:512
    ds_read_b64_tr_b16 v[30:31], v7 offset:3072
    ds_read_b64_tr_b16 v[32:33], v7 offset:1024
    ds_read_b64_tr_b16 v[34:35], v7 offset:3584
    ds_read_b128 v[36:39], v5 offset:4096
    ds_read_b128 v[40:43], v5 offset:4352
    ds_read_b64_tr_b16 v[44:45], v7 offset:5120
    ds_read_b64_tr_b16 v[46:47], v7 offset:7680
    ds_read_b64_tr_b16 v[48:49], v7 offset:5632
    ds_read_b64_tr_b16 v[50:51], v7 offset:8192
    ds_read_b64_tr_b16 v[52:53], v7 offset:6144
    ds_read_b64_tr_b16 v[54:55], v7 offset:8704
    s_waitcnt lgkmcnt(0)
    s_barrier
    v_mfma_f32_16x16x32_bf16 v[96:99], v[24:27], v[16:19], 0
    ds_read_b128 v[56:59], v5 offset:18432
    ds_read_b128 v[60:63], v5 offset:18688
    v_mfma_f32_16x16x32_bf16 v[100:103], v[24:27], v[20:23], 0
    ds_read_b64_tr_b16 v[64:65], v7 offset:18432
    ds_read_b64_tr_b16 v[66:67], v7 offset:20992
    v_mfma_f32_16x16x32_bf16 v[104:107], v[28:31], v[16:19], 0
    ds_read_b64_tr_b16 v[68:69], v7 offset:18944
    ds_read_b64_tr_b16 v[70:71], v7 offset:21504
    v_mfma_f32_16x16x32_bf16 v[108:111], v[28:31], v[20:23], 0
    ds_read_b64_tr_b16 v[72:73], v7 offset:19456
    ds_read_b64_tr_b16 v[74:75], v7 offset:22016
    v_mfma_f32_16x16x32_bf16 v[112:115], v[32:35], v[16:19], 0
    ds_read_b128 v[76:79], v5 offset:22528
    ds_read_b128 v[80:83], v5 offset:22784
    v_mfma_f32_16x16x32_bf16 v[116:119], v[32:35], v[20:23], 0
    ds_read_b64_tr_b16 v[84:85], v7 offset:23552
    ds_read_b64_tr_b16 v[86:87], v7 offset:26112
    v_mfma_f32_16x16x32_bf16 v[96:99], v[44:47], v[36:39], v[96:99]
    ds_read_b64_tr_b16 v[88:89], v7 offset:24064
    ds_read_b64_tr_b16 v[90:91], v7 offset:26624
    v_mfma_f32_16x16x32_bf16 v[100:103], v[44:47], v[40:43], v[100:103]
    ds_read_b64_tr_b16 v[92:93], v7 offset:24576
    ds_read_b64_tr_b16 v[94:95], v7 offset:27136
    v_mfma_f32_16x16x32_bf16 v[104:107], v[48:51], v[36:39], v[104:107]
    v_mfma_f32_16x16x32_bf16 v[108:111], v[48:51], v[40:43], v[108:111]
    v_mfma_f32_16x16x32_bf16 v[112:115], v[52:55], v[36:39], v[112:115]
    v_mfma_f32_16x16x32_bf16 v[116:119], v[52:55], v[40:43], v[116:119]
    s_waitcnt lgkmcnt(0)
    s_barrier
    v_mfma_f32_16x16x32_bf16 v[96:99], v[64:67], v[56:59], v[96:99]
    ds_read_b128 v[16:19], v5 offset:36864
    ds_read_b128 v[20:23], v5 offset:37120
    v_mfma_f32_16x16x32_bf16 v[100:103], v[64:67], v[60:63], v[100:103]
    ds_read_b64_tr_b16 v[24:25], v7 offset:36864
    ds_read_b64_tr_b16 v[26:27], v7 offset:39424
    v_mfma_f32_16x16x32_bf16 v[104:107], v[68:71], v[56:59], v[104:107]
    ds_read_b64_tr_b16 v[28:29], v7 offset:37376
    ds_read_b64_tr_b16 v[30:31], v7 offset:39936
    v_mfma_f32_16x16x32_bf16 v[108:111], v[68:71], v[60:63], v[108:111]
    ds_read_b64_tr_b16 v[32:33], v7 offset:37888
    ds_read_b64_tr_b16 v[34:35], v7 offset:40448
    v_mfma_f32_16x16x32_bf16 v[112:115], v[72:75], v[56:59], v[112:115]
    ds_read_b128 v[36:39], v5 offset:40960
    ds_read_b128 v[40:43], v5 offset:41216
    v_mfma_f32_16x16x32_bf16 v[116:119], v[72:75], v[60:63], v[116:119]
    ds_read_b64_tr_b16 v[44:45], v7 offset:41984
    ds_read_b64_tr_b16 v[46:47], v7 offset:44544
    v_mfma_f32_16x16x32_bf16 v[96:99], v[84:87], v[76:79], v[96:99]
    ds_read_b64_tr_b16 v[48:49], v7 offset:42496
    ds_read_b64_tr_b16 v[50:51], v7 offset:45056
    v_mfma_f32_16x16x32_bf16 v[100:103], v[84:87], v[80:83], v[100:103]
    ds_read_b64_tr_b16 v[52:53], v7 offset:43008
    ds_read_b64_tr_b16 v[54:55], v7 offset:45568
    v_mfma_f32_16x16x32_bf16 v[104:107], v[88:91], v[76:79], v[104:107]
    v_mfma_f32_16x16x32_bf16 v[108:111], v[88:91], v[80:83], v[108:111]
    v_mfma_f32_16x16x32_bf16 v[112:115], v[92:95], v[76:79], v[112:115]
    v_mfma_f32_16x16x32_bf16 v[116:119], v[92:95], v[80:83], v[116:119]
    s_waitcnt vmcnt(0)
    s_lshl_b32 s56, s34, 2
    s_add_u32 s56, s56, s35
    s_lshl_b32 s56, s56, 8
    s_lshl_b32 s57, s33, 3
    s_add_u32 s56, s56, s57
    s_lshl_b32 s57, s36, 2
    s_add_u32 s56, s56, s57
    s_add_u32 s56, s56, 13770752
    v_mov_b32 v184, 0
    v_mov_b32 v185, 1
    s_mov_b64 exec, 1
    buffer_store_dword v185, v184, s[8:11], s56 offen sc1
    s_mov_b64 exec, -1
    s_waitcnt lgkmcnt(0)
    s_barrier
    v_mfma_f32_16x16x32_bf16 v[96:99], v[24:27], v[16:19], v[96:99]
    ds_read_b128 v[56:59], v4 offset:0
    ds_read_b128 v[60:63], v4 offset:256
    v_mfma_f32_16x16x32_bf16 v[100:103], v[24:27], v[20:23], v[100:103]
    ds_read_b64_tr_b16 v[64:65], v6 offset:0
    ds_read_b64_tr_b16 v[66:67], v6 offset:2560
    v_mfma_f32_16x16x32_bf16 v[104:107], v[28:31], v[16:19], v[104:107]
    ds_read_b64_tr_b16 v[68:69], v6 offset:512
    ds_read_b64_tr_b16 v[70:71], v6 offset:3072
    v_mfma_f32_16x16x32_bf16 v[108:111], v[28:31], v[20:23], v[108:111]
    ds_read_b64_tr_b16 v[72:73], v6 offset:1024
    ds_read_b64_tr_b16 v[74:75], v6 offset:3584
    v_mfma_f32_16x16x32_bf16 v[112:115], v[32:35], v[16:19], v[112:115]
    ds_read_b128 v[76:79], v4 offset:4096
    ds_read_b128 v[80:83], v4 offset:4352
    v_mfma_f32_16x16x32_bf16 v[116:119], v[32:35], v[20:23], v[116:119]
    ds_read_b64_tr_b16 v[84:85], v6 offset:5120
    ds_read_b64_tr_b16 v[86:87], v6 offset:7680
    v_mfma_f32_16x16x32_bf16 v[96:99], v[44:47], v[36:39], v[96:99]
    ds_read_b64_tr_b16 v[88:89], v6 offset:5632
    ds_read_b64_tr_b16 v[90:91], v6 offset:8192
    v_mfma_f32_16x16x32_bf16 v[100:103], v[44:47], v[40:43], v[100:103]
    ds_read_b64_tr_b16 v[92:93], v6 offset:6144
    ds_read_b64_tr_b16 v[94:95], v6 offset:8704
    v_mfma_f32_16x16x32_bf16 v[104:107], v[48:51], v[36:39], v[104:107]
    v_mfma_f32_16x16x32_bf16 v[108:111], v[48:51], v[40:43], v[108:111]
    v_mfma_f32_16x16x32_bf16 v[112:115], v[52:55], v[36:39], v[112:115]
    v_mfma_f32_16x16x32_bf16 v[116:119], v[52:55], v[40:43], v[116:119]
    s_waitcnt lgkmcnt(0)
    s_barrier
    v_mfma_f32_16x16x32_bf16 v[96:99], v[64:67], v[56:59], v[96:99]
    ds_read_b128 v[16:19], v4 offset:18432
    ds_read_b128 v[20:23], v4 offset:18688
    v_mfma_f32_16x16x32_bf16 v[100:103], v[64:67], v[60:63], v[100:103]
    ds_read_b64_tr_b16 v[24:25], v6 offset:18432
    ds_read_b64_tr_b16 v[26:27], v6 offset:20992
    v_mfma_f32_16x16x32_bf16 v[104:107], v[68:71], v[56:59], v[104:107]
    ds_read_b64_tr_b16 v[28:29], v6 offset:18944
    ds_read_b64_tr_b16 v[30:31], v6 offset:21504
    v_mfma_f32_16x16x32_bf16 v[108:111], v[68:71], v[60:63], v[108:111]
    ds_read_b64_tr_b16 v[32:33], v6 offset:19456
    ds_read_b64_tr_b16 v[34:35], v6 offset:22016
    v_mfma_f32_16x16x32_bf16 v[112:115], v[72:75], v[56:59], v[112:115]
    ds_read_b128 v[36:39], v4 offset:22528
    ds_read_b128 v[40:43], v4 offset:22784
    v_mfma_f32_16x16x32_bf16 v[116:119], v[72:75], v[60:63], v[116:119]
    ds_read_b64_tr_b16 v[44:45], v6 offset:23552
    ds_read_b64_tr_b16 v[46:47], v6 offset:26112
    v_mfma_f32_16x16x32_bf16 v[96:99], v[84:87], v[76:79], v[96:99]
    ds_read_b64_tr_b16 v[48:49], v6 offset:24064
    ds_read_b64_tr_b16 v[50:51], v6 offset:26624
    v_mfma_f32_16x16x32_bf16 v[100:103], v[84:87], v[80:83], v[100:103]
    ds_read_b64_tr_b16 v[52:53], v6 offset:24576
    ds_read_b64_tr_b16 v[54:55], v6 offset:27136
    v_mfma_f32_16x16x32_bf16 v[104:107], v[88:91], v[76:79], v[104:107]
    v_mfma_f32_16x16x32_bf16 v[108:111], v[88:91], v[80:83], v[108:111]
    v_mfma_f32_16x16x32_bf16 v[112:115], v[92:95], v[76:79], v[112:115]
    v_mfma_f32_16x16x32_bf16 v[116:119], v[92:95], v[80:83], v[116:119]
    s_waitcnt lgkmcnt(0)
    s_barrier
    v_mfma_f32_16x16x32_bf16 v[96:99], v[24:27], v[16:19], v[96:99]
    ds_read_b128 v[56:59], v4 offset:36864
    ds_read_b128 v[60:63], v4 offset:37120
    v_mfma_f32_16x16x32_bf16 v[100:103], v[24:27], v[20:23], v[100:103]
    ds_read_b64_tr_b16 v[64:65], v6 offset:36864
    ds_read_b64_tr_b16 v[66:67], v6 offset:39424
    v_mfma_f32_16x16x32_bf16 v[104:107], v[28:31], v[16:19], v[104:107]
    ds_read_b64_tr_b16 v[68:69], v6 offset:37376
    ds_read_b64_tr_b16 v[70:71], v6 offset:39936
    v_mfma_f32_16x16x32_bf16 v[108:111], v[28:31], v[20:23], v[108:111]
    ds_read_b64_tr_b16 v[72:73], v6 offset:37888
    ds_read_b64_tr_b16 v[74:75], v6 offset:40448
    v_mfma_f32_16x16x32_bf16 v[112:115], v[32:35], v[16:19], v[112:115]
    ds_read_b128 v[76:79], v4 offset:40960
    ds_read_b128 v[80:83], v4 offset:41216
    v_mfma_f32_16x16x32_bf16 v[116:119], v[32:35], v[20:23], v[116:119]
    ds_read_b64_tr_b16 v[84:85], v6 offset:41984
    ds_read_b64_tr_b16 v[86:87], v6 offset:44544
    v_mfma_f32_16x16x32_bf16 v[96:99], v[44:47], v[36:39], v[96:99]
    ds_read_b64_tr_b16 v[88:89], v6 offset:42496
    ds_read_b64_tr_b16 v[90:91], v6 offset:45056
    v_mfma_f32_16x16x32_bf16 v[100:103], v[44:47], v[40:43], v[100:103]
    ds_read_b64_tr_b16 v[92:93], v6 offset:43008
    ds_read_b64_tr_b16 v[94:95], v6 offset:45568
    v_mfma_f32_16x16x32_bf16 v[104:107], v[48:51], v[36:39], v[104:107]
    v_mfma_f32_16x16x32_bf16 v[108:111], v[48:51], v[40:43], v[108:111]
    v_mfma_f32_16x16x32_bf16 v[112:115], v[52:55], v[36:39], v[112:115]
    v_mfma_f32_16x16x32_bf16 v[116:119], v[52:55], v[40:43], v[116:119]
    s_waitcnt lgkmcnt(0)
    s_barrier
    v_mfma_f32_16x16x32_bf16 v[96:99], v[64:67], v[56:59], v[96:99]
    ds_read_b128 v[16:19], v4 offset:55296
    ds_read_b128 v[20:23], v4 offset:55552
    v_mfma_f32_16x16x32_bf16 v[100:103], v[64:67], v[60:63], v[100:103]
    ds_read_b64_tr_b16 v[24:25], v6 offset:55296
    ds_read_b64_tr_b16 v[26:27], v6 offset:57856
    v_mfma_f32_16x16x32_bf16 v[104:107], v[68:71], v[56:59], v[104:107]
    ds_read_b64_tr_b16 v[28:29], v6 offset:55808
    ds_read_b64_tr_b16 v[30:31], v6 offset:58368
    v_mfma_f32_16x16x32_bf16 v[108:111], v[68:71], v[60:63], v[108:111]
    ds_read_b64_tr_b16 v[32:33], v6 offset:56320
    ds_read_b64_tr_b16 v[34:35], v6 offset:58880
    v_mfma_f32_16x16x32_bf16 v[112:115], v[72:75], v[56:59], v[112:115]
    ds_read_b128 v[36:39], v4 offset:59392
    ds_read_b128 v[40:43], v4 offset:59648
    v_mfma_f32_16x16x32_bf16 v[116:119], v[72:75], v[60:63], v[116:119]
    ds_read_b64_tr_b16 v[44:45], v6 offset:60416
    ds_read_b64_tr_b16 v[46:47], v6 offset:62976
    v_mfma_f32_16x16x32_bf16 v[96:99], v[84:87], v[76:79], v[96:99]
    ds_read_b64_tr_b16 v[48:49], v6 offset:60928
    ds_read_b64_tr_b16 v[50:51], v6 offset:63488
    v_mfma_f32_16x16x32_bf16 v[100:103], v[84:87], v[80:83], v[100:103]
    ds_read_b64_tr_b16 v[52:53], v6 offset:61440
    ds_read_b64_tr_b16 v[54:55], v6 offset:64000
    v_mfma_f32_16x16x32_bf16 v[104:107], v[88:91], v[76:79], v[104:107]
    v_mfma_f32_16x16x32_bf16 v[108:111], v[88:91], v[80:83], v[108:111]
    v_mfma_f32_16x16x32_bf16 v[112:115], v[92:95], v[76:79], v[112:115]
    v_mfma_f32_16x16x32_bf16 v[116:119], v[92:95], v[80:83], v[116:119]
    s_waitcnt lgkmcnt(0)
    s_barrier
    v_mfma_f32_16x16x32_bf16 v[96:99], v[24:27], v[16:19], v[96:99]
    ds_read_b128 v[56:59], v5 offset:0
    ds_read_b128 v[60:63], v5 offset:256
    v_mfma_f32_16x16x32_bf16 v[100:103], v[24:27], v[20:23], v[100:103]
    ds_read_b64_tr_b16 v[64:65], v7 offset:0
    ds_read_b64_tr_b16 v[66:67], v7 offset:2560
    v_mfma_f32_16x16x32_bf16 v[104:107], v[28:31], v[16:19], v[104:107]
    ds_read_b64_tr_b16 v[68:69], v7 offset:512
    ds_read_b64_tr_b16 v[70:71], v7 offset:3072
    v_mfma_f32_16x16x32_bf16 v[108:111], v[28:31], v[20:23], v[108:111]
    ds_read_b64_tr_b16 v[72:73], v7 offset:1024
    ds_read_b64_tr_b16 v[74:75], v7 offset:3584
    v_mfma_f32_16x16x32_bf16 v[112:115], v[32:35], v[16:19], v[112:115]
    ds_read_b128 v[76:79], v5 offset:4096
    ds_read_b128 v[80:83], v5 offset:4352
    v_mfma_f32_16x16x32_bf16 v[116:119], v[32:35], v[20:23], v[116:119]
    ds_read_b64_tr_b16 v[84:85], v7 offset:5120
    ds_read_b64_tr_b16 v[86:87], v7 offset:7680
    v_mfma_f32_16x16x32_bf16 v[96:99], v[44:47], v[36:39], v[96:99]
    ds_read_b64_tr_b16 v[88:89], v7 offset:5632
    ds_read_b64_tr_b16 v[90:91], v7 offset:8192
    v_mfma_f32_16x16x32_bf16 v[100:103], v[44:47], v[40:43], v[100:103]
    ds_read_b64_tr_b16 v[92:93], v7 offset:6144
    ds_read_b64_tr_b16 v[94:95], v7 offset:8704
    v_mfma_f32_16x16x32_bf16 v[104:107], v[48:51], v[36:39], v[104:107]
    v_mfma_f32_16x16x32_bf16 v[108:111], v[48:51], v[40:43], v[108:111]
    v_mfma_f32_16x16x32_bf16 v[112:115], v[52:55], v[36:39], v[112:115]
    v_mfma_f32_16x16x32_bf16 v[116:119], v[52:55], v[40:43], v[116:119]
    s_waitcnt lgkmcnt(0)
    s_barrier
    v_mfma_f32_16x16x32_bf16 v[96:99], v[64:67], v[56:59], v[96:99]
    ds_read_b128 v[16:19], v5 offset:18432
    ds_read_b128 v[20:23], v5 offset:18688
    v_mfma_f32_16x16x32_bf16 v[100:103], v[64:67], v[60:63], v[100:103]
    ds_read_b64_tr_b16 v[24:25], v7 offset:18432
    ds_read_b64_tr_b16 v[26:27], v7 offset:20992
    v_mfma_f32_16x16x32_bf16 v[104:107], v[68:71], v[56:59], v[104:107]
    ds_read_b64_tr_b16 v[28:29], v7 offset:18944
    ds_read_b64_tr_b16 v[30:31], v7 offset:21504
    v_mfma_f32_16x16x32_bf16 v[108:111], v[68:71], v[60:63], v[108:111]
    ds_read_b64_tr_b16 v[32:33], v7 offset:19456
    ds_read_b64_tr_b16 v[34:35], v7 offset:22016
    v_mfma_f32_16x16x32_bf16 v[112:115], v[72:75], v[56:59], v[112:115]
    ds_read_b128 v[36:39], v5 offset:22528
    ds_read_b128 v[40:43], v5 offset:22784
    v_mfma_f32_16x16x32_bf16 v[116:119], v[72:75], v[60:63], v[116:119]
    ds_read_b64_tr_b16 v[44:45], v7 offset:23552
    ds_read_b64_tr_b16 v[46:47], v7 offset:26112
    v_mfma_f32_16x16x32_bf16 v[96:99], v[84:87], v[76:79], v[96:99]
    ds_read_b64_tr_b16 v[48:49], v7 offset:24064
    ds_read_b64_tr_b16 v[50:51], v7 offset:26624
    v_mfma_f32_16x16x32_bf16 v[100:103], v[84:87], v[80:83], v[100:103]
    ds_read_b64_tr_b16 v[52:53], v7 offset:24576
    ds_read_b64_tr_b16 v[54:55], v7 offset:27136
    v_mfma_f32_16x16x32_bf16 v[104:107], v[88:91], v[76:79], v[104:107]
    v_mfma_f32_16x16x32_bf16 v[108:111], v[88:91], v[80:83], v[108:111]
    v_mfma_f32_16x16x32_bf16 v[112:115], v[92:95], v[76:79], v[112:115]
    v_mfma_f32_16x16x32_bf16 v[116:119], v[92:95], v[80:83], v[116:119]
    s_waitcnt lgkmcnt(0)
    s_barrier
    v_mfma_f32_16x16x32_bf16 v[96:99], v[24:27], v[16:19], v[96:99]
    ds_read_b128 v[56:59], v5 offset:36864
    ds_read_b128 v[60:63], v5 offset:37120
    v_mfma_f32_16x16x32_bf16 v[100:103], v[24:27], v[20:23], v[100:103]
    ds_read_b64_tr_b16 v[64:65], v7 offset:36864
    ds_read_b64_tr_b16 v[66:67], v7 offset:39424
    v_mfma_f32_16x16x32_bf16 v[104:107], v[28:31], v[16:19], v[104:107]
    ds_read_b64_tr_b16 v[68:69], v7 offset:37376
    ds_read_b64_tr_b16 v[70:71], v7 offset:39936
    v_mfma_f32_16x16x32_bf16 v[108:111], v[28:31], v[20:23], v[108:111]
    ds_read_b64_tr_b16 v[72:73], v7 offset:37888
    ds_read_b64_tr_b16 v[74:75], v7 offset:40448
    v_mfma_f32_16x16x32_bf16 v[112:115], v[32:35], v[16:19], v[112:115]
    ds_read_b128 v[76:79], v5 offset:40960
    ds_read_b128 v[80:83], v5 offset:41216
    v_mfma_f32_16x16x32_bf16 v[116:119], v[32:35], v[20:23], v[116:119]
    ds_read_b64_tr_b16 v[84:85], v7 offset:41984
    ds_read_b64_tr_b16 v[86:87], v7 offset:44544
    v_mfma_f32_16x16x32_bf16 v[96:99], v[44:47], v[36:39], v[96:99]
    ds_read_b64_tr_b16 v[88:89], v7 offset:42496
    ds_read_b64_tr_b16 v[90:91], v7 offset:45056
    v_mfma_f32_16x16x32_bf16 v[100:103], v[44:47], v[40:43], v[100:103]
    ds_read_b64_tr_b16 v[92:93], v7 offset:43008
    ds_read_b64_tr_b16 v[94:95], v7 offset:45568
    v_mfma_f32_16x16x32_bf16 v[104:107], v[48:51], v[36:39], v[104:107]
    v_mfma_f32_16x16x32_bf16 v[108:111], v[48:51], v[40:43], v[108:111]
    v_mfma_f32_16x16x32_bf16 v[112:115], v[52:55], v[36:39], v[112:115]
    v_mfma_f32_16x16x32_bf16 v[116:119], v[52:55], v[40:43], v[116:119]
    s_waitcnt lgkmcnt(0)
    s_barrier
    v_mfma_f32_16x16x32_bf16 v[96:99], v[64:67], v[56:59], v[96:99]
    ds_read_b128 v[16:19], v4 offset:0
    ds_read_b128 v[20:23], v4 offset:256
    v_mfma_f32_16x16x32_bf16 v[100:103], v[64:67], v[60:63], v[100:103]
    ds_read_b64_tr_b16 v[24:25], v6 offset:0
    ds_read_b64_tr_b16 v[26:27], v6 offset:2560
    v_mfma_f32_16x16x32_bf16 v[104:107], v[68:71], v[56:59], v[104:107]
    ds_read_b64_tr_b16 v[28:29], v6 offset:512
    ds_read_b64_tr_b16 v[30:31], v6 offset:3072
    v_mfma_f32_16x16x32_bf16 v[108:111], v[68:71], v[60:63], v[108:111]
    ds_read_b64_tr_b16 v[32:33], v6 offset:1024
    ds_read_b64_tr_b16 v[34:35], v6 offset:3584
    v_mfma_f32_16x16x32_bf16 v[112:115], v[72:75], v[56:59], v[112:115]
    ds_read_b128 v[36:39], v4 offset:4096
    ds_read_b128 v[40:43], v4 offset:4352
    v_mfma_f32_16x16x32_bf16 v[116:119], v[72:75], v[60:63], v[116:119]
    ds_read_b64_tr_b16 v[44:45], v6 offset:5120
    ds_read_b64_tr_b16 v[46:47], v6 offset:7680
    v_mfma_f32_16x16x32_bf16 v[96:99], v[84:87], v[76:79], v[96:99]
    ds_read_b64_tr_b16 v[48:49], v6 offset:5632
    ds_read_b64_tr_b16 v[50:51], v6 offset:8192
    v_mfma_f32_16x16x32_bf16 v[100:103], v[84:87], v[80:83], v[100:103]
    ds_read_b64_tr_b16 v[52:53], v6 offset:6144
    ds_read_b64_tr_b16 v[54:55], v6 offset:8704
    v_mfma_f32_16x16x32_bf16 v[104:107], v[88:91], v[76:79], v[104:107]
    v_mfma_f32_16x16x32_bf16 v[108:111], v[88:91], v[80:83], v[108:111]
    v_mfma_f32_16x16x32_bf16 v[112:115], v[92:95], v[76:79], v[112:115]
    v_mfma_f32_16x16x32_bf16 v[116:119], v[92:95], v[80:83], v[116:119]
    v_cvt_pk_bf16_f32 v124, v96, v97
    v_cvt_pk_bf16_f32 v125, v98, v99
    ds_write_b64 v10, v[124:125] offset:0
    v_cvt_pk_bf16_f32 v126, v100, v101
    v_cvt_pk_bf16_f32 v127, v102, v103
    ds_write_b64 v10, v[126:127] offset:2560
    v_cvt_pk_bf16_f32 v128, v104, v105
    v_cvt_pk_bf16_f32 v129, v106, v107
    ds_write_b64 v10, v[128:129] offset:32
    v_cvt_pk_bf16_f32 v130, v108, v109
    v_cvt_pk_bf16_f32 v131, v110, v111
    ds_write_b64 v10, v[130:131] offset:2592
    v_cvt_pk_bf16_f32 v124, v112, v113
    v_cvt_pk_bf16_f32 v125, v114, v115
    ds_write_b64 v10, v[124:125] offset:64
    v_cvt_pk_bf16_f32 v126, v116, v117
    v_cvt_pk_bf16_f32 v127, v118, v119
    ds_write_b64 v10, v[126:127] offset:2624
    s_waitcnt lgkmcnt(0)
    s_barrier
    s_add_u32 s51, s50, 0
    ds_read_b128 v[144:147], v12
    ds_read_b128 v[148:151], v13
    ds_read_b128 v[152:155], v14
    s_waitcnt lgkmcnt(1)
    buffer_store_dwordx4 v[144:147], v140, s[28:31], s51 offen nt
    buffer_store_dwordx4 v[148:151], v141, s[28:31], s51 offen nt
    s_cmp_ge_u32 s35, 2
    s_cbranch_scc1 p3o_65
    s_waitcnt lgkmcnt(0)
    buffer_store_dwordx4 v[152:155], v142, s[28:31], s51 offen nt
p3o_65:
    s_waitcnt lgkmcnt(0)
    s_barrier
    v_mfma_f32_16x16x32_bf16 v[96:99], v[24:27], v[16:19], 0
    ds_read_b128 v[56:59], v4 offset:18432
    ds_read_b128 v[60:63], v4 offset:18688
    v_mfma_f32_16x16x32_bf16 v[100:103], v[24:27], v[20:23], 0
    ds_read_b64_tr_b16 v[64:65], v6 offset:18432
    ds_read_b64_tr_b16 v[66:67], v6 offset:20992
    v_mfma_f32_16x16x32_bf16 v[104:107], v[28:31], v[16:19], 0
    ds_read_b64_tr_b16 v[68:69], v6 offset:18944
    ds_read_b64_tr_b16 v[70:71], v6 offset:21504
    v_mfma_f32_16x16x32_bf16 v[108:111], v[28:31], v[20:23], 0
    ds_read_b64_tr_b16 v[72:73], v6 offset:19456
    ds_read_b64_tr_b16 v[74:75], v6 offset:22016
    v_mfma_f32_16x16x32_bf16 v[112:115], v[32:35], v[16:19], 0
    ds_read_b128 v[76:79], v4 offset:22528
    ds_read_b128 v[80:83], v4 offset:22784
    v_mfma_f32_16x16x32_bf16 v[116:119], v[32:35], v[20:23], 0
    ds_read_b64_tr_b16 v[84:85], v6 offset:23552
    ds_read_b64_tr_b16 v[86:87], v6 offset:26112
    v_mfma_f32_16x16x32_bf16 v[96:99], v[44:47], v[36:39], v[96:99]
    ds_read_b64_tr_b16 v[88:89], v6 offset:24064
    ds_read_b64_tr_b16 v[90:91], v6 offset:26624
    v_mfma_f32_16x16x32_bf16 v[100:103], v[44:47], v[40:43], v[100:103]
    ds_read_b64_tr_b16 v[92:93], v6 offset:24576
    ds_read_b64_tr_b16 v[94:95], v6 offset:27136
    v_mfma_f32_16x16x32_bf16 v[104:107], v[48:51], v[36:39], v[104:107]
    v_mfma_f32_16x16x32_bf16 v[108:111], v[48:51], v[40:43], v[108:111]
    v_mfma_f32_16x16x32_bf16 v[112:115], v[52:55], v[36:39], v[112:115]
    v_mfma_f32_16x16x32_bf16 v[116:119], v[52:55], v[40:43], v[116:119]
    s_waitcnt lgkmcnt(0)
    s_barrier
    v_mfma_f32_16x16x32_bf16 v[96:99], v[64:67], v[56:59], v[96:99]
    ds_read_b128 v[16:19], v4 offset:36864
    ds_read_b128 v[20:23], v4 offset:37120
    v_mfma_f32_16x16x32_bf16 v[100:103], v[64:67], v[60:63], v[100:103]
    ds_read_b64_tr_b16 v[24:25], v6 offset:36864
    ds_read_b64_tr_b16 v[26:27], v6 offset:39424
    v_mfma_f32_16x16x32_bf16 v[104:107], v[68:71], v[56:59], v[104:107]
    ds_read_b64_tr_b16 v[28:29], v6 offset:37376
    ds_read_b64_tr_b16 v[30:31], v6 offset:39936
    v_mfma_f32_16x16x32_bf16 v[108:111], v[68:71], v[60:63], v[108:111]
    ds_read_b64_tr_b16 v[32:33], v6 offset:37888
    ds_read_b64_tr_b16 v[34:35], v6 offset:40448
    v_mfma_f32_16x16x32_bf16 v[112:115], v[72:75], v[56:59], v[112:115]
    ds_read_b128 v[36:39], v4 offset:40960
    ds_read_b128 v[40:43], v4 offset:41216
    v_mfma_f32_16x16x32_bf16 v[116:119], v[72:75], v[60:63], v[116:119]
    ds_read_b64_tr_b16 v[44:45], v6 offset:41984
    ds_read_b64_tr_b16 v[46:47], v6 offset:44544
    v_mfma_f32_16x16x32_bf16 v[96:99], v[84:87], v[76:79], v[96:99]
    ds_read_b64_tr_b16 v[48:49], v6 offset:42496
    ds_read_b64_tr_b16 v[50:51], v6 offset:45056
    v_mfma_f32_16x16x32_bf16 v[100:103], v[84:87], v[80:83], v[100:103]
    ds_read_b64_tr_b16 v[52:53], v6 offset:43008
    ds_read_b64_tr_b16 v[54:55], v6 offset:45568
    v_mfma_f32_16x16x32_bf16 v[104:107], v[88:91], v[76:79], v[104:107]
    v_mfma_f32_16x16x32_bf16 v[108:111], v[88:91], v[80:83], v[108:111]
    v_mfma_f32_16x16x32_bf16 v[112:115], v[92:95], v[76:79], v[112:115]
    v_mfma_f32_16x16x32_bf16 v[116:119], v[92:95], v[80:83], v[116:119]
    s_waitcnt lgkmcnt(0)
    s_barrier
    v_mfma_f32_16x16x32_bf16 v[96:99], v[24:27], v[16:19], v[96:99]
    ds_read_b128 v[56:59], v4 offset:55296
    ds_read_b128 v[60:63], v4 offset:55552
    v_mfma_f32_16x16x32_bf16 v[100:103], v[24:27], v[20:23], v[100:103]
    ds_read_b64_tr_b16 v[64:65], v6 offset:55296
    ds_read_b64_tr_b16 v[66:67], v6 offset:57856
    v_mfma_f32_16x16x32_bf16 v[104:107], v[28:31], v[16:19], v[104:107]
    ds_read_b64_tr_b16 v[68:69], v6 offset:55808
    ds_read_b64_tr_b16 v[70:71], v6 offset:58368
    v_mfma_f32_16x16x32_bf16 v[108:111], v[28:31], v[20:23], v[108:111]
    ds_read_b64_tr_b16 v[72:73], v6 offset:56320
    ds_read_b64_tr_b16 v[74:75], v6 offset:58880
    v_mfma_f32_16x16x32_bf16 v[112:115], v[32:35], v[16:19], v[112:115]
    ds_read_b128 v[76:79], v4 offset:59392
    ds_read_b128 v[80:83], v4 offset:59648
    v_mfma_f32_16x16x32_bf16 v[116:119], v[32:35], v[20:23], v[116:119]
    ds_read_b64_tr_b16 v[84:85], v6 offset:60416
    ds_read_b64_tr_b16 v[86:87], v6 offset:62976
    v_mfma_f32_16x16x32_bf16 v[96:99], v[44:47], v[36:39], v[96:99]
    ds_read_b64_tr_b16 v[88:89], v6 offset:60928
    ds_read_b64_tr_b16 v[90:91], v6 offset:63488
    v_mfma_f32_16x16x32_bf16 v[100:103], v[44:47], v[40:43], v[100:103]
    ds_read_b64_tr_b16 v[92:93], v6 offset:61440
    ds_read_b64_tr_b16 v[94:95], v6 offset:64000
    v_mfma_f32_16x16x32_bf16 v[104:107], v[48:51], v[36:39], v[104:107]
    v_mfma_f32_16x16x32_bf16 v[108:111], v[48:51], v[40:43], v[108:111]
    v_mfma_f32_16x16x32_bf16 v[112:115], v[52:55], v[36:39], v[112:115]
    v_mfma_f32_16x16x32_bf16 v[116:119], v[52:55], v[40:43], v[116:119]
    s_waitcnt lgkmcnt(0)
    s_barrier
    v_mfma_f32_16x16x32_bf16 v[96:99], v[64:67], v[56:59], v[96:99]
    ds_read_b128 v[16:19], v5 offset:0
    ds_read_b128 v[20:23], v5 offset:256
    v_mfma_f32_16x16x32_bf16 v[100:103], v[64:67], v[60:63], v[100:103]
    ds_read_b64_tr_b16 v[24:25], v7 offset:0
    ds_read_b64_tr_b16 v[26:27], v7 offset:2560
    v_mfma_f32_16x16x32_bf16 v[104:107], v[68:71], v[56:59], v[104:107]
    ds_read_b64_tr_b16 v[28:29], v7 offset:512
    ds_read_b64_tr_b16 v[30:31], v7 offset:3072
    v_mfma_f32_16x16x32_bf16 v[108:111], v[68:71], v[60:63], v[108:111]
    ds_read_b64_tr_b16 v[32:33], v7 offset:1024
    ds_read_b64_tr_b16 v[34:35], v7 offset:3584
    v_mfma_f32_16x16x32_bf16 v[112:115], v[72:75], v[56:59], v[112:115]
    ds_read_b128 v[36:39], v5 offset:4096
    ds_read_b128 v[40:43], v5 offset:4352
    v_mfma_f32_16x16x32_bf16 v[116:119], v[72:75], v[60:63], v[116:119]
    ds_read_b64_tr_b16 v[44:45], v7 offset:5120
    ds_read_b64_tr_b16 v[46:47], v7 offset:7680
    v_mfma_f32_16x16x32_bf16 v[96:99], v[84:87], v[76:79], v[96:99]
    ds_read_b64_tr_b16 v[48:49], v7 offset:5632
    ds_read_b64_tr_b16 v[50:51], v7 offset:8192
    v_mfma_f32_16x16x32_bf16 v[100:103], v[84:87], v[80:83], v[100:103]
    ds_read_b64_tr_b16 v[52:53], v7 offset:6144
    ds_read_b64_tr_b16 v[54:55], v7 offset:8704
    v_mfma_f32_16x16x32_bf16 v[104:107], v[88:91], v[76:79], v[104:107]
    v_mfma_f32_16x16x32_bf16 v[108:111], v[88:91], v[80:83], v[108:111]
    v_mfma_f32_16x16x32_bf16 v[112:115], v[92:95], v[76:79], v[112:115]
    v_mfma_f32_16x16x32_bf16 v[116:119], v[92:95], v[80:83], v[116:119]
    s_waitcnt lgkmcnt(0)
    s_barrier
    v_mfma_f32_16x16x32_bf16 v[96:99], v[24:27], v[16:19], v[96:99]
    ds_read_b128 v[56:59], v5 offset:18432
    ds_read_b128 v[60:63], v5 offset:18688
    v_mfma_f32_16x16x32_bf16 v[100:103], v[24:27], v[20:23], v[100:103]
    ds_read_b64_tr_b16 v[64:65], v7 offset:18432
    ds_read_b64_tr_b16 v[66:67], v7 offset:20992
    v_mfma_f32_16x16x32_bf16 v[104:107], v[28:31], v[16:19], v[104:107]
    ds_read_b64_tr_b16 v[68:69], v7 offset:18944
    ds_read_b64_tr_b16 v[70:71], v7 offset:21504
    v_mfma_f32_16x16x32_bf16 v[108:111], v[28:31], v[20:23], v[108:111]
    ds_read_b64_tr_b16 v[72:73], v7 offset:19456
    ds_read_b64_tr_b16 v[74:75], v7 offset:22016
    v_mfma_f32_16x16x32_bf16 v[112:115], v[32:35], v[16:19], v[112:115]
    ds_read_b128 v[76:79], v5 offset:22528
    ds_read_b128 v[80:83], v5 offset:22784
    v_mfma_f32_16x16x32_bf16 v[116:119], v[32:35], v[20:23], v[116:119]
    ds_read_b64_tr_b16 v[84:85], v7 offset:23552
    ds_read_b64_tr_b16 v[86:87], v7 offset:26112
    v_mfma_f32_16x16x32_bf16 v[96:99], v[44:47], v[36:39], v[96:99]
    ds_read_b64_tr_b16 v[88:89], v7 offset:24064
    ds_read_b64_tr_b16 v[90:91], v7 offset:26624
    v_mfma_f32_16x16x32_bf16 v[100:103], v[44:47], v[40:43], v[100:103]
    ds_read_b64_tr_b16 v[92:93], v7 offset:24576
    ds_read_b64_tr_b16 v[94:95], v7 offset:27136
    v_mfma_f32_16x16x32_bf16 v[104:107], v[48:51], v[36:39], v[104:107]
    v_mfma_f32_16x16x32_bf16 v[108:111], v[48:51], v[40:43], v[108:111]
    v_mfma_f32_16x16x32_bf16 v[112:115], v[52:55], v[36:39], v[112:115]
    v_mfma_f32_16x16x32_bf16 v[116:119], v[52:55], v[40:43], v[116:119]
    s_waitcnt lgkmcnt(0)
    s_barrier
    v_mfma_f32_16x16x32_bf16 v[96:99], v[64:67], v[56:59], v[96:99]
    ds_read_b128 v[16:19], v5 offset:36864
    ds_read_b128 v[20:23], v5 offset:37120
    v_mfma_f32_16x16x32_bf16 v[100:103], v[64:67], v[60:63], v[100:103]
    ds_read_b64_tr_b16 v[24:25], v7 offset:36864
    ds_read_b64_tr_b16 v[26:27], v7 offset:39424
    v_mfma_f32_16x16x32_bf16 v[104:107], v[68:71], v[56:59], v[104:107]
    ds_read_b64_tr_b16 v[28:29], v7 offset:37376
    ds_read_b64_tr_b16 v[30:31], v7 offset:39936
    v_mfma_f32_16x16x32_bf16 v[108:111], v[68:71], v[60:63], v[108:111]
    ds_read_b64_tr_b16 v[32:33], v7 offset:37888
    ds_read_b64_tr_b16 v[34:35], v7 offset:40448
    v_mfma_f32_16x16x32_bf16 v[112:115], v[72:75], v[56:59], v[112:115]
    ds_read_b128 v[36:39], v5 offset:40960
    ds_read_b128 v[40:43], v5 offset:41216
    v_mfma_f32_16x16x32_bf16 v[116:119], v[72:75], v[60:63], v[116:119]
    ds_read_b64_tr_b16 v[44:45], v7 offset:41984
    ds_read_b64_tr_b16 v[46:47], v7 offset:44544
    v_mfma_f32_16x16x32_bf16 v[96:99], v[84:87], v[76:79], v[96:99]
    ds_read_b64_tr_b16 v[48:49], v7 offset:42496
    ds_read_b64_tr_b16 v[50:51], v7 offset:45056
    v_mfma_f32_16x16x32_bf16 v[100:103], v[84:87], v[80:83], v[100:103]
    ds_read_b64_tr_b16 v[52:53], v7 offset:43008
    ds_read_b64_tr_b16 v[54:55], v7 offset:45568
    v_mfma_f32_16x16x32_bf16 v[104:107], v[88:91], v[76:79], v[104:107]
    v_mfma_f32_16x16x32_bf16 v[108:111], v[88:91], v[80:83], v[108:111]
    v_mfma_f32_16x16x32_bf16 v[112:115], v[92:95], v[76:79], v[112:115]
    v_mfma_f32_16x16x32_bf16 v[116:119], v[92:95], v[80:83], v[116:119]
    s_waitcnt lgkmcnt(0)
    s_barrier
    v_mfma_f32_16x16x32_bf16 v[96:99], v[24:27], v[16:19], v[96:99]
    ds_read_b128 v[56:59], v4 offset:0
    ds_read_b128 v[60:63], v4 offset:256
    v_mfma_f32_16x16x32_bf16 v[100:103], v[24:27], v[20:23], v[100:103]
    ds_read_b64_tr_b16 v[64:65], v6 offset:0
    ds_read_b64_tr_b16 v[66:67], v6 offset:2560
    v_mfma_f32_16x16x32_bf16 v[104:107], v[28:31], v[16:19], v[104:107]
    ds_read_b64_tr_b16 v[68:69], v6 offset:512
    ds_read_b64_tr_b16 v[70:71], v6 offset:3072
    v_mfma_f32_16x16x32_bf16 v[108:111], v[28:31], v[20:23], v[108:111]
    ds_read_b64_tr_b16 v[72:73], v6 offset:1024
    ds_read_b64_tr_b16 v[74:75], v6 offset:3584
    v_mfma_f32_16x16x32_bf16 v[112:115], v[32:35], v[16:19], v[112:115]
    ds_read_b128 v[76:79], v4 offset:4096
    ds_read_b128 v[80:83], v4 offset:4352
    v_mfma_f32_16x16x32_bf16 v[116:119], v[32:35], v[20:23], v[116:119]
    ds_read_b64_tr_b16 v[84:85], v6 offset:5120
    ds_read_b64_tr_b16 v[86:87], v6 offset:7680
    v_mfma_f32_16x16x32_bf16 v[96:99], v[44:47], v[36:39], v[96:99]
    ds_read_b64_tr_b16 v[88:89], v6 offset:5632
    ds_read_b64_tr_b16 v[90:91], v6 offset:8192
    v_mfma_f32_16x16x32_bf16 v[100:103], v[44:47], v[40:43], v[100:103]
    ds_read_b64_tr_b16 v[92:93], v6 offset:6144
    ds_read_b64_tr_b16 v[94:95], v6 offset:8704
    v_mfma_f32_16x16x32_bf16 v[104:107], v[48:51], v[36:39], v[104:107]
    v_mfma_f32_16x16x32_bf16 v[108:111], v[48:51], v[40:43], v[108:111]
    v_mfma_f32_16x16x32_bf16 v[112:115], v[52:55], v[36:39], v[112:115]
    v_mfma_f32_16x16x32_bf16 v[116:119], v[52:55], v[40:43], v[116:119]
    s_waitcnt lgkmcnt(0)
    s_barrier
    v_mfma_f32_16x16x32_bf16 v[96:99], v[64:67], v[56:59], v[96:99]
    ds_read_b128 v[16:19], v4 offset:18432
    ds_read_b128 v[20:23], v4 offset:18688
    v_mfma_f32_16x16x32_bf16 v[100:103], v[64:67], v[60:63], v[100:103]
    ds_read_b64_tr_b16 v[24:25], v6 offset:18432
    ds_read_b64_tr_b16 v[26:27], v6 offset:20992
    v_mfma_f32_16x16x32_bf16 v[104:107], v[68:71], v[56:59], v[104:107]
    ds_read_b64_tr_b16 v[28:29], v6 offset:18944
    ds_read_b64_tr_b16 v[30:31], v6 offset:21504
    v_mfma_f32_16x16x32_bf16 v[108:111], v[68:71], v[60:63], v[108:111]
    ds_read_b64_tr_b16 v[32:33], v6 offset:19456
    ds_read_b64_tr_b16 v[34:35], v6 offset:22016
    v_mfma_f32_16x16x32_bf16 v[112:115], v[72:75], v[56:59], v[112:115]
    ds_read_b128 v[36:39], v4 offset:22528
    ds_read_b128 v[40:43], v4 offset:22784
    v_mfma_f32_16x16x32_bf16 v[116:119], v[72:75], v[60:63], v[116:119]
    ds_read_b64_tr_b16 v[44:45], v6 offset:23552
    ds_read_b64_tr_b16 v[46:47], v6 offset:26112
    v_mfma_f32_16x16x32_bf16 v[96:99], v[84:87], v[76:79], v[96:99]
    ds_read_b64_tr_b16 v[48:49], v6 offset:24064
    ds_read_b64_tr_b16 v[50:51], v6 offset:26624
    v_mfma_f32_16x16x32_bf16 v[100:103], v[84:87], v[80:83], v[100:103]
    ds_read_b64_tr_b16 v[52:53], v6 offset:24576
    ds_read_b64_tr_b16 v[54:55], v6 offset:27136
    v_mfma_f32_16x16x32_bf16 v[104:107], v[88:91], v[76:79], v[104:107]
    v_mfma_f32_16x16x32_bf16 v[108:111], v[88:91], v[80:83], v[108:111]
    v_mfma_f32_16x16x32_bf16 v[112:115], v[92:95], v[76:79], v[112:115]
    v_mfma_f32_16x16x32_bf16 v[116:119], v[92:95], v[80:83], v[116:119]
    s_waitcnt lgkmcnt(0)
    s_barrier
    v_mfma_f32_16x16x32_bf16 v[96:99], v[24:27], v[16:19], v[96:99]
    ds_read_b128 v[56:59], v4 offset:36864
    ds_read_b128 v[60:63], v4 offset:37120
    v_mfma_f32_16x16x32_bf16 v[100:103], v[24:27], v[20:23], v[100:103]
    ds_read_b64_tr_b16 v[64:65], v6 offset:36864
    ds_read_b64_tr_b16 v[66:67], v6 offset:39424
    v_mfma_f32_16x16x32_bf16 v[104:107], v[28:31], v[16:19], v[104:107]
    ds_read_b64_tr_b16 v[68:69], v6 offset:37376
    ds_read_b64_tr_b16 v[70:71], v6 offset:39936
    v_mfma_f32_16x16x32_bf16 v[108:111], v[28:31], v[20:23], v[108:111]
    ds_read_b64_tr_b16 v[72:73], v6 offset:37888
    ds_read_b64_tr_b16 v[74:75], v6 offset:40448
    v_mfma_f32_16x16x32_bf16 v[112:115], v[32:35], v[16:19], v[112:115]
    ds_read_b128 v[76:79], v4 offset:40960
    ds_read_b128 v[80:83], v4 offset:41216
    v_mfma_f32_16x16x32_bf16 v[116:119], v[32:35], v[20:23], v[116:119]
    ds_read_b64_tr_b16 v[84:85], v6 offset:41984
    ds_read_b64_tr_b16 v[86:87], v6 offset:44544
    v_mfma_f32_16x16x32_bf16 v[96:99], v[44:47], v[36:39], v[96:99]
    ds_read_b64_tr_b16 v[88:89], v6 offset:42496
    ds_read_b64_tr_b16 v[90:91], v6 offset:45056
    v_mfma_f32_16x16x32_bf16 v[100:103], v[44:47], v[40:43], v[100:103]
    ds_read_b64_tr_b16 v[92:93], v6 offset:43008
    ds_read_b64_tr_b16 v[94:95], v6 offset:45568
    v_mfma_f32_16x16x32_bf16 v[104:107], v[48:51], v[36:39], v[104:107]
    v_mfma_f32_16x16x32_bf16 v[108:111], v[48:51], v[40:43], v[108:111]
    v_mfma_f32_16x16x32_bf16 v[112:115], v[52:55], v[36:39], v[112:115]
    v_mfma_f32_16x16x32_bf16 v[116:119], v[52:55], v[40:43], v[116:119]
    s_waitcnt lgkmcnt(0)
    s_barrier
    v_mfma_f32_16x16x32_bf16 v[96:99], v[64:67], v[56:59], v[96:99]
    v_mfma_f32_16x16x32_bf16 v[100:103], v[64:67], v[60:63], v[100:103]
    v_mfma_f32_16x16x32_bf16 v[104:107], v[68:71], v[56:59], v[104:107]
    v_mfma_f32_16x16x32_bf16 v[108:111], v[68:71], v[60:63], v[108:111]
    v_mfma_f32_16x16x32_bf16 v[112:115], v[72:75], v[56:59], v[112:115]
    v_mfma_f32_16x16x32_bf16 v[116:119], v[72:75], v[60:63], v[116:119]
    v_mfma_f32_16x16x32_bf16 v[96:99], v[84:87], v[76:79], v[96:99]
    v_mfma_f32_16x16x32_bf16 v[100:103], v[84:87], v[80:83], v[100:103]
    v_mfma_f32_16x16x32_bf16 v[104:107], v[88:91], v[76:79], v[104:107]
    v_mfma_f32_16x16x32_bf16 v[108:111], v[88:91], v[80:83], v[108:111]
    v_mfma_f32_16x16x32_bf16 v[112:115], v[92:95], v[76:79], v[112:115]
    v_mfma_f32_16x16x32_bf16 v[116:119], v[92:95], v[80:83], v[116:119]
    s_nop 2
    v_cvt_pk_bf16_f32 v124, v96, v97
    v_cvt_pk_bf16_f32 v125, v98, v99
    ds_write_b64 v10, v[124:125] offset:0
    v_cvt_pk_bf16_f32 v126, v100, v101
    v_cvt_pk_bf16_f32 v127, v102, v103
    ds_write_b64 v10, v[126:127] offset:2560
    v_cvt_pk_bf16_f32 v128, v104, v105
    v_cvt_pk_bf16_f32 v129, v106, v107
    ds_write_b64 v10, v[128:129] offset:32
    v_cvt_pk_bf16_f32 v130, v108, v109
    v_cvt_pk_bf16_f32 v131, v110, v111
    ds_write_b64 v10, v[130:131] offset:2592
    v_cvt_pk_bf16_f32 v124, v112, v113
    v_cvt_pk_bf16_f32 v125, v114, v115
    ds_write_b64 v10, v[124:125] offset:64
    v_cvt_pk_bf16_f32 v126, v116, v117
    v_cvt_pk_bf16_f32 v127, v118, v119
    ds_write_b64 v10, v[126:127] offset:2624
    s_waitcnt lgkmcnt(0)
    s_barrier
    s_add_u32 s51, s50, 1280
    ds_read_b128 v[144:147], v12
    ds_read_b128 v[148:151], v13
    ds_read_b128 v[152:155], v14
    s_waitcnt lgkmcnt(1)
    buffer_store_dwordx4 v[144:147], v140, s[28:31], s51 offen nt
    buffer_store_dwordx4 v[148:151], v141, s[28:31], s51 offen nt
    s_cmp_ge_u32 s35, 2
    s_cbranch_scc1 p3o_66
    s_waitcnt lgkmcnt(0)
    buffer_store_dwordx4 v[152:155], v142, s[28:31], s51 offen nt
p3o_66:
    s_branch concat_heads__linear_kernel_hedgehog__mha_block__prompt_kernel_p3done
concat_heads__linear_kernel_hedgehog__mha_block__prompt_kernel_p3load:
    s_waitcnt vmcnt(3)
    s_barrier
    s_lshl_b32 s56, s35, 10
    s_add_u32 s56, s56, 24576
    s_cmp_le_u32 s100, 3
    s_cselect_b32 s58, 81920, 0
    s_add_u32 s57, s94, 24576
    s_sub_u32 s57, s57, s58
    s_mov_b32 m0, s56
    s_add_u32 s58, s57, 4096
    buffer_load_dwordx4 v2, s[8:11], s57 offen sc1 lds
    s_add_u32 m0, s56, 4096
    s_nop 0
    buffer_load_dwordx4 v2, s[8:11], s58 offen sc1 lds
    s_cmp_le_u32 s100, 3
    s_cselect_b32 s58, 102400, 0
    s_add_u32 s57, s95, 30720
    s_sub_u32 s57, s57, s58
    s_add_u32 m0, s56, 8192
    s_add_u32 s58, s57, 4096
    buffer_load_dwordx4 v2, s[8:11], s57 offen sc1 lds
    s_add_u32 m0, s56, 12288
    s_add_u32 s57, s57, 8192
    buffer_load_dwordx4 v2, s[8:11], s58 offen sc1 lds
    s_cmp_ge_u32 s35, 2
    s_cbranch_scc1 p3w_67
    s_add_u32 m0, s56, 16384
    s_nop 0
    buffer_load_dwordx4 v2, s[8:11], s57 offen sc1 lds
p3w_67:
    s_lshl_b32 s56, s35, 10
    s_add_u32 s56, s56, 43008
    s_cmp_le_u32 s100, 4
    s_cselect_b32 s58, 81920, 0
    s_add_u32 s57, s94, 32768
    s_sub_u32 s57, s57, s58
    s_mov_b32 m0, s56
    s_add_u32 s58, s57, 4096
    buffer_load_dwordx4 v2, s[8:11], s57 offen sc1 lds
    s_add_u32 m0, s56, 4096
    s_nop 0
    buffer_load_dwordx4 v2, s[8:11], s58 offen sc1 lds
    s_cmp_le_u32 s100, 4
    s_cselect_b32 s58, 102400, 0
    s_add_u32 s57, s95, 40960
    s_sub_u32 s57, s57, s58
    s_add_u32 m0, s56, 8192
    s_add_u32 s58, s57, 4096
    buffer_load_dwordx4 v2, s[8:11], s57 offen sc1 lds
    s_add_u32 m0, s56, 12288
    s_add_u32 s57, s57, 8192
    buffer_load_dwordx4 v2, s[8:11], s58 offen sc1 lds
    s_cmp_ge_u32 s35, 2
    s_cbranch_scc1 p3w_68
    s_add_u32 m0, s56, 16384
    s_nop 0
    buffer_load_dwordx4 v2, s[8:11], s57 offen sc1 lds
p3w_68:
    s_nop 0
    s_barrier
    s_lshl_b32 s56, s35, 10
    s_add_u32 s56, s56, 61440
    s_cmp_le_u32 s100, 5
    s_cselect_b32 s58, 81920, 0
    s_add_u32 s57, s94, 40960
    s_sub_u32 s57, s57, s58
    s_mov_b32 m0, s56
    s_add_u32 s58, s57, 4096
    buffer_load_dwordx4 v2, s[8:11], s57 offen sc1 lds
    s_add_u32 m0, s56, 4096
    s_nop 0
    buffer_load_dwordx4 v2, s[8:11], s58 offen sc1 lds
    s_cmp_le_u32 s100, 5
    s_cselect_b32 s58, 102400, 0
    s_add_u32 s57, s95, 51200
    s_sub_u32 s57, s57, s58
    s_add_u32 m0, s56, 8192
    s_add_u32 s58, s57, 4096
    buffer_load_dwordx4 v2, s[8:11], s57 offen sc1 lds
    s_add_u32 m0, s56, 12288
    s_add_u32 s57, s57, 8192
    buffer_load_dwordx4 v2, s[8:11], s58 offen sc1 lds
    s_cmp_ge_u32 s35, 2
    s_cbranch_scc1 p3w_69
    s_add_u32 m0, s56, 16384
    s_nop 0
    buffer_load_dwordx4 v2, s[8:11], s57 offen sc1 lds
p3w_69:
    s_lshl_b32 s56, s35, 10
    s_add_u32 s56, s56, 79872
    s_cmp_le_u32 s100, 6
    s_cselect_b32 s58, 81920, 0
    s_add_u32 s57, s94, 49152
    s_sub_u32 s57, s57, s58
    s_mov_b32 m0, s56
    s_add_u32 s58, s57, 4096
    buffer_load_dwordx4 v2, s[8:11], s57 offen sc1 lds
    s_add_u32 m0, s56, 4096
    s_nop 0
    buffer_load_dwordx4 v2, s[8:11], s58 offen sc1 lds
    s_cmp_le_u32 s100, 6
    s_cselect_b32 s58, 102400, 0
    s_add_u32 s57, s95, 61440
    s_sub_u32 s57, s57, s58
    s_add_u32 m0, s56, 8192
    s_add_u32 s58, s57, 4096
    buffer_load_dwordx4 v2, s[8:11], s57 offen sc1 lds
    s_add_u32 m0, s56, 12288
    s_add_u32 s57, s57, 8192
    buffer_load_dwordx4 v2, s[8:11], s58 offen sc1 lds
    s_cmp_ge_u32 s35, 2
    s_cbranch_scc1 p3w_70
    s_add_u32 m0, s56, 16384
    s_nop 0
    buffer_load_dwordx4 v2, s[8:11], s57 offen sc1 lds
p3w_70:
    s_waitcnt vmcnt(16)
    s_lshl_b32 s56, s34, 2
    s_add_u32 s56, s56, s35
    s_lshl_b32 s56, s56, 8
    s_lshl_b32 s57, s33, 3
    s_add_u32 s56, s56, s57
    s_lshl_b32 s57, s36, 2
    s_add_u32 s56, s56, s57
    s_add_u32 s56, s56, 13770752
    v_mov_b32 v184, 0
    v_mov_b32 v185, 1
    s_mov_b64 exec, 1
    buffer_store_dword v185, v184, s[8:11], s56 offen sc1
    s_mov_b64 exec, -1
    s_nop 0
    s_barrier
    s_lshl_b32 s56, s35, 10
    s_add_u32 s56, s56, 98304
    s_cmp_le_u32 s100, 7
    s_cselect_b32 s58, 81920, 0
    s_add_u32 s57, s94, 57344
    s_sub_u32 s57, s57, s58
    s_mov_b32 m0, s56
    s_add_u32 s58, s57, 4096
    buffer_load_dwordx4 v2, s[8:11], s57 offen sc1 lds
    s_add_u32 m0, s56, 4096
    s_nop 0
    buffer_load_dwordx4 v2, s[8:11], s58 offen sc1 lds
    s_cmp_le_u32 s100, 7
    s_cselect_b32 s58, 102400, 0
    s_add_u32 s57, s95, 71680
    s_sub_u32 s57, s57, s58
    s_add_u32 m0, s56, 8192
    s_add_u32 s58, s57, 4096
    buffer_load_dwordx4 v2, s[8:11], s57 offen sc1 lds
    s_add_u32 m0, s56, 12288
    s_add_u32 s57, s57, 8192
    buffer_load_dwordx4 v2, s[8:11], s58 offen sc1 lds
    s_cmp_ge_u32 s35, 2
    s_cbranch_scc1 p3w_71
    s_add_u32 m0, s56, 16384
    s_nop 0
    buffer_load_dwordx4 v2, s[8:11], s57 offen sc1 lds
p3w_71:
    s_lshl_b32 s56, s35, 10
    s_add_u32 s56, s56, 116736
    s_cmp_le_u32 s100, 8
    s_cselect_b32 s58, 81920, 0
    s_add_u32 s57, s94, 65536
    s_sub_u32 s57, s57, s58
    s_mov_b32 m0, s56
    s_add_u32 s58, s57, 4096
    buffer_load_dwordx4 v2, s[8:11], s57 offen sc1 lds
    s_add_u32 m0, s56, 4096
    s_nop 0
    buffer_load_dwordx4 v2, s[8:11], s58 offen sc1 lds
    s_cmp_le_u32 s100, 8
    s_cselect_b32 s58, 102400, 0
    s_add_u32 s57, s95, 81920
    s_sub_u32 s57, s57, s58
    s_add_u32 m0, s56, 8192
    s_add_u32 s58, s57, 4096
    buffer_load_dwordx4 v2, s[8:11], s57 offen sc1 lds
    s_add_u32 m0, s56, 12288
    s_add_u32 s57, s57, 8192
    buffer_load_dwordx4 v2, s[8:11], s58 offen sc1 lds
    s_cmp_ge_u32 s35, 2
    s_cbranch_scc1 p3w_72
    s_add_u32 m0, s56, 16384
    s_nop 0
    buffer_load_dwordx4 v2, s[8:11], s57 offen sc1 lds
p3w_72:
    s_waitcnt vmcnt(21)
    s_barrier
    s_lshl_b32 s56, s35, 10
    s_add_u32 s56, s56, 135168
    s_cmp_le_u32 s100, 9
    s_cselect_b32 s58, 81920, 0
    s_add_u32 s57, s94, 73728
    s_sub_u32 s57, s57, s58
    s_mov_b32 m0, s56
    s_add_u32 s58, s57, 4096
    buffer_load_dwordx4 v2, s[8:11], s57 offen sc1 lds
    s_add_u32 m0, s56, 4096
    s_nop 0
    buffer_load_dwordx4 v2, s[8:11], s58 offen sc1 lds
    s_cmp_le_u32 s100, 9
    s_cselect_b32 s58, 102400, 0
    s_add_u32 s57, s95, 92160
    s_sub_u32 s57, s57, s58
    s_add_u32 m0, s56, 8192
    s_add_u32 s58, s57, 4096
    buffer_load_dwordx4 v2, s[8:11], s57 offen sc1 lds
    s_add_u32 m0, s56, 12288
    s_add_u32 s57, s57, 8192
    buffer_load_dwordx4 v2, s[8:11], s58 offen sc1 lds
    s_cmp_ge_u32 s35, 2
    s_cbranch_scc1 p3w_73
    s_add_u32 m0, s56, 16384
    s_nop 0
    buffer_load_dwordx4 v2, s[8:11], s57 offen sc1 lds
p3w_73:
    s_waitcnt vmcnt(21)
    s_barrier
    s_lshl_b32 s56, s35, 10
    s_add_u32 s56, s56, 24576
    s_cmp_le_u32 s100, 0
    s_cselect_b32 s58, 102400, 0
    s_add_u32 s57, s95, 819200
    s_sub_u32 s57, s57, s58
    s_add_u32 m0, s56, 8192
    s_add_u32 s58, s57, 4096
    buffer_load_dwordx4 v2, s[8:11], s57 offen sc1 lds
    s_add_u32 m0, s56, 12288
    s_add_u32 s57, s57, 8192
    buffer_load_dwordx4 v2, s[8:11], s58 offen sc1 lds
    s_cmp_ge_u32 s35, 2
    s_cbranch_scc1 p3w_74
    s_add_u32 m0, s56, 16384
    s_nop 0
    buffer_load_dwordx4 v2, s[8:11], s57 offen sc1 lds
p3w_74:
    s_waitcnt vmcnt(19)
    s_barrier
    s_lshl_b32 s56, s35, 10
    s_add_u32 s56, s56, 43008
    s_cmp_le_u32 s100, 1
    s_cselect_b32 s58, 102400, 0
    s_add_u32 s57, s95, 829440
    s_sub_u32 s57, s57, s58
    s_add_u32 m0, s56, 8192
    s_add_u32 s58, s57, 4096
    buffer_load_dwordx4 v2, s[8:11], s57 offen sc1 lds
    s_add_u32 m0, s56, 12288
    s_add_u32 s57, s57, 8192
    buffer_load_dwordx4 v2, s[8:11], s58 offen sc1 lds
    s_cmp_ge_u32 s35, 2
    s_cbranch_scc1 p3w_75
    s_add_u32 m0, s56, 16384
    s_nop 0
    buffer_load_dwordx4 v2, s[8:11], s57 offen sc1 lds
p3w_75:
    s_waitcnt vmcnt(17)
    s_barrier
    s_lshl_b32 s56, s35, 10
    s_add_u32 s56, s56, 61440
    s_cmp_le_u32 s100, 2
    s_cselect_b32 s58, 102400, 0
    s_add_u32 s57, s95, 839680
    s_sub_u32 s57, s57, s58
    s_add_u32 m0, s56, 8192
    s_add_u32 s58, s57, 4096
    buffer_load_dwordx4 v2, s[8:11], s57 offen sc1 lds
    s_add_u32 m0, s56, 12288
    s_add_u32 s57, s57, 8192
    buffer_load_dwordx4 v2, s[8:11], s58 offen sc1 lds
    s_cmp_ge_u32 s35, 2
    s_cbranch_scc1 p3w_76
    s_add_u32 m0, s56, 16384
    s_nop 0
    buffer_load_dwordx4 v2, s[8:11], s57 offen sc1 lds
p3w_76:
    s_waitcnt vmcnt(14)
    s_barrier
    s_lshl_b32 s56, s35, 10
    s_add_u32 s56, s56, 79872
    s_cmp_le_u32 s100, 3
    s_cselect_b32 s58, 102400, 0
    s_add_u32 s57, s95, 849920
    s_sub_u32 s57, s57, s58
    s_add_u32 m0, s56, 8192
    s_add_u32 s58, s57, 4096
    buffer_load_dwordx4 v2, s[8:11], s57 offen sc1 lds
    s_add_u32 m0, s56, 12288
    s_add_u32 s57, s57, 8192
    buffer_load_dwordx4 v2, s[8:11], s58 offen sc1 lds
    s_cmp_ge_u32 s35, 2
    s_cbranch_scc1 p3w_77
    s_add_u32 m0, s56, 16384
    s_nop 0
    buffer_load_dwordx4 v2, s[8:11], s57 offen sc1 lds
p3w_77:
    s_waitcnt vmcnt(12)
    s_barrier
    s_lshl_b32 s56, s35, 10
    s_add_u32 s56, s56, 98304
    s_cmp_le_u32 s100, 4
    s_cselect_b32 s58, 102400, 0
    s_add_u32 s57, s95, 860160
    s_sub_u32 s57, s57, s58
    s_add_u32 m0, s56, 8192
    s_add_u32 s58, s57, 4096
    buffer_load_dwordx4 v2, s[8:11], s57 offen sc1 lds
    s_add_u32 m0, s56, 12288
    s_add_u32 s57, s57, 8192
    buffer_load_dwordx4 v2, s[8:11], s58 offen sc1 lds
    s_cmp_ge_u32 s35, 2
    s_cbranch_scc1 p3w_78
    s_add_u32 m0, s56, 16384
    s_nop 0
    buffer_load_dwordx4 v2, s[8:11], s57 offen sc1 lds
p3w_78:
    s_lshl_b32 s55, s33, 8
    s_add_u32 s55, s55, 13770752
    buffer_load_dword v208, v191, s[8:11], s55 offen sc1
    s_waitcnt vmcnt(11)
    s_barrier
    s_lshl_b32 s56, s35, 10
    s_add_u32 s56, s56, 116736
    s_cmp_le_u32 s100, 5
    s_cselect_b32 s58, 102400, 0
    s_add_u32 s57, s95, 870400
    s_sub_u32 s57, s57, s58
    s_add_u32 m0, s56, 8192
    s_add_u32 s58, s57, 4096
    buffer_load_dwordx4 v2, s[8:11], s57 offen sc1 lds
    s_add_u32 m0, s56, 12288
    s_add_u32 s57, s57, 8192
    buffer_load_dwordx4 v2, s[8:11], s58 offen sc1 lds
    s_cmp_ge_u32 s35, 2
    s_cbranch_scc1 p3w_79
    s_add_u32 m0, s56, 16384
    s_nop 0
    buffer_load_dwordx4 v2, s[8:11], s57 offen sc1 lds
p3w_79:
    s_lshl_b32 s55, s33, 8
    s_add_u32 s55, s55, 13770752
    s_waitcnt vmcnt(2)
    v_cmp_eq_u32 vcc, 1, v208
    s_cmp_eq_u64 vcc, -1
    s_cbranch_scc1 fc_80
    buffer_load_dword v208, v191, s[8:11], s55 offen sc1
    s_waitcnt vmcnt(0)
    v_cmp_eq_u32 vcc, 1, v208
    s_cmp_eq_u64 vcc, -1
    s_cbranch_scc1 pw_81_ok
    s_mov_b32 s59, 0
pw_81:
    s_sleep 8
    buffer_load_dword v208, v191, s[8:11], s55 offen sc1
    s_waitcnt vmcnt(0)
    v_cmp_eq_u32 vcc, 1, v208
    s_cmp_eq_u64 vcc, -1
    s_cbranch_scc1 pw_81_ok
    s_add_u32 s59, s59, 1
    s_cmp_lt_u32 s59, 50000
    s_cbranch_scc1 pw_81
pw_81_ok:
fc_80:
    s_lshl_b32 s56, s35, 10
    s_add_u32 s56, s56, 24576
    s_cmp_le_u32 s100, 0
    s_cselect_b32 s58, 81920, 0
    s_add_u32 s57, s94, 16777216
    s_sub_u32 s57, s57, s58
    s_mov_b32 m0, s56
    s_add_u32 s58, s57, 4096
    buffer_load_dwordx4 v2, s[8:11], s57 offen sc1 lds
    s_add_u32 m0, s56, 4096
    s_nop 0
    buffer_load_dwordx4 v2, s[8:11], s58 offen sc1 lds
    s_lshl_b32 s56, s35, 10
    s_add_u32 s56, s56, 43008
    s_cmp_le_u32 s100, 1
    s_cselect_b32 s58, 81920, 0
    s_add_u32 s57, s94, 16785408
    s_sub_u32 s57, s57, s58
    s_mov_b32 m0, s56
    s_add_u32 s58, s57, 4096
    buffer_load_dwordx4 v2, s[8:11], s57 offen sc1 lds
    s_add_u32 m0, s56, 4096
    s_nop 0
    buffer_load_dwordx4 v2, s[8:11], s58 offen sc1 lds
    s_lshl_b32 s56, s35, 10
    s_add_u32 s56, s56, 61440
    s_cmp_le_u32 s100, 2
    s_cselect_b32 s58, 81920, 0
    s_add_u32 s57, s94, 16793600
    s_sub_u32 s57, s57, s58
    s_mov_b32 m0, s56
    s_add_u32 s58, s57, 4096
    buffer_load_dwordx4 v2, s[8:11], s57 offen sc1 lds
    s_add_u32 m0, s56, 4096
    s_nop 0
    buffer_load_dwordx4 v2, s[8:11], s58 offen sc1 lds
    s_lshl_b32 s56, s35, 10
    s_add_u32 s56, s56, 79872
    s_cmp_le_u32 s100, 3
    s_cselect_b32 s58, 81920, 0
    s_add_u32 s57, s94, 16801792
    s_sub_u32 s57, s57, s58
    s_mov_b32 m0, s56
    s_add_u32 s58, s57, 4096
    buffer_load_dwordx4 v2, s[8:11], s57 offen sc1 lds
    s_add_u32 m0, s56, 4096
    s_nop 0
    buffer_load_dwordx4 v2, s[8:11], s58 offen sc1 lds
    s_lshl_b32 s56, s35, 10
    s_add_u32 s56, s56, 98304
    s_cmp_le_u32 s100, 4
    s_cselect_b32 s58, 81920, 0
    s_add_u32 s57, s94, 16809984
    s_sub_u32 s57, s57, s58
    s_mov_b32 m0, s56
    s_add_u32 s58, s57, 4096
    buffer_load_dwordx4 v2, s[8:11], s57 offen sc1 lds
    s_add_u32 m0, s56, 4096
    s_nop 0
    buffer_load_dwordx4 v2, s[8:11], s58 offen sc1 lds
    s_lshl_b32 s56, s35, 10
    s_add_u32 s56, s56, 116736
    s_cmp_le_u32 s100, 5
    s_cselect_b32 s58, 81920, 0
    s_add_u32 s57, s94, 16818176
    s_sub_u32 s57, s57, s58
    s_mov_b32 m0, s56
    s_add_u32 s58, s57, 4096
    buffer_load_dwordx4 v2, s[8:11], s57 offen sc1 lds
    s_add_u32 m0, s56, 4096
    s_nop 0
    buffer_load_dwordx4 v2, s[8:11], s58 offen sc1 lds
    s_waitcnt vmcnt(10)
    s_barrier
    s_lshl_b32 s56, s35, 10
    s_add_u32 s56, s56, 135168
    s_cmp_le_u32 s100, 6
    s_cselect_b32 s58, 81920, 0
    s_add_u32 s57, s94, 16826368
    s_sub_u32 s57, s57, s58
    s_mov_b32 m0, s56
    s_add_u32 s58, s57, 4096
    buffer_load_dwordx4 v2, s[8:11], s57 offen sc1 lds
    s_add_u32 m0, s56, 4096
    s_nop 0
    buffer_load_dwordx4 v2, s[8:11], s58 offen sc1 lds
    s_cmp_le_u32 s100, 6
    s_cselect_b32 s58, 102400, 0
    s_add_u32 s57, s95, 880640
    s_sub_u32 s57, s57, s58
    s_add_u32 m0, s56, 8192
    s_add_u32 s58, s57, 4096
    buffer_load_dwordx4 v2, s[8:11], s57 offen sc1 lds
    s_add_u32 m0, s56, 12288
    s_add_u32 s57, s57, 8192
    buffer_load_dwordx4 v2, s[8:11], s58 offen sc1 lds
    s_cmp_ge_u32 s35, 2
    s_cbranch_scc1 p3w_82
    s_add_u32 m0, s56, 16384
    s_nop 0
    buffer_load_dwordx4 v2, s[8:11], s57 offen sc1 lds
p3w_82:
    s_barrier
    s_waitcnt vmcnt(12)
    s_barrier
    s_lshl_b32 s56, s35, 10
    s_add_u32 s56, s56, 24576
    s_cmp_le_u32 s100, 7
    s_cselect_b32 s58, 81920, 0
    s_add_u32 s57, s94, 16834560
    s_sub_u32 s57, s57, s58
    s_mov_b32 m0, s56
    s_add_u32 s58, s57, 4096
    buffer_load_dwordx4 v2, s[8:11], s57 offen sc1 lds
    s_add_u32 m0, s56, 4096
    s_nop 0
    buffer_load_dwordx4 v2, s[8:11], s58 offen sc1 lds
    s_cmp_le_u32 s100, 7
    s_cselect_b32 s58, 102400, 0
    s_add_u32 s57, s95, 890880
    s_sub_u32 s57, s57, s58
    s_add_u32 m0, s56, 8192
    s_add_u32 s58, s57, 4096
    buffer_load_dwordx4 v2, s[8:11], s57 offen sc1 lds
    s_add_u32 m0, s56, 12288
    s_add_u32 s57, s57, 8192
    buffer_load_dwordx4 v2, s[8:11], s58 offen sc1 lds
    s_cmp_ge_u32 s35, 2
    s_cbranch_scc1 p3w_83
    s_add_u32 m0, s56, 16384
    s_nop 0
    buffer_load_dwordx4 v2, s[8:11], s57 offen sc1 lds
p3w_83:
    s_waitcnt vmcnt(14)
    s_barrier
    s_lshl_b32 s56, s35, 10
    s_add_u32 s56, s56, 43008
    s_cmp_le_u32 s100, 8
    s_cselect_b32 s58, 81920, 0
    s_add_u32 s57, s94, 16842752
    s_sub_u32 s57, s57, s58
    s_mov_b32 m0, s56
    s_add_u32 s58, s57, 4096
    buffer_load_dwordx4 v2, s[8:11], s57 offen sc1 lds
    s_add_u32 m0, s56, 4096
    s_nop 0
    buffer_load_dwordx4 v2, s[8:11], s58 offen sc1 lds
    s_cmp_le_u32 s100, 8
    s_cselect_b32 s58, 102400, 0
    s_add_u32 s57, s95, 901120
    s_sub_u32 s57, s57, s58
    s_add_u32 m0, s56, 8192
    s_add_u32 s58, s57, 4096
    buffer_load_dwordx4 v2, s[8:11], s57 offen sc1 lds
    s_add_u32 m0, s56, 12288
    s_add_u32 s57, s57, 8192
    buffer_load_dwordx4 v2, s[8:11], s58 offen sc1 lds
    s_cmp_ge_u32 s35, 2
    s_cbranch_scc1 p3w_84
    s_add_u32 m0, s56, 16384
    s_nop 0
    buffer_load_dwordx4 v2, s[8:11], s57 offen sc1 lds
p3w_84:
    s_waitcnt vmcnt(16)
    s_barrier
    s_lshl_b32 s56, s35, 10
    s_add_u32 s56, s56, 61440
    s_cmp_le_u32 s100, 9
    s_cselect_b32 s58, 81920, 0
    s_add_u32 s57, s94, 16850944
    s_sub_u32 s57, s57, s58
    s_mov_b32 m0, s56
    s_add_u32 s58, s57, 4096
    buffer_load_dwordx4 v2, s[8:11], s57 offen sc1 lds
    s_add_u32 m0, s56, 4096
    s_nop 0
    buffer_load_dwordx4 v2, s[8:11], s58 offen sc1 lds
    s_cmp_le_u32 s100, 9
    s_cselect_b32 s58, 102400, 0
    s_add_u32 s57, s95, 911360
    s_sub_u32 s57, s57, s58
    s_add_u32 m0, s56, 8192
    s_add_u32 s58, s57, 4096
    buffer_load_dwordx4 v2, s[8:11], s57 offen sc1 lds
    s_add_u32 m0, s56, 12288
    s_add_u32 s57, s57, 8192
    buffer_load_dwordx4 v2, s[8:11], s58 offen sc1 lds
    s_cmp_ge_u32 s35, 2
    s_cbranch_scc1 p3w_85
    s_add_u32 m0, s56, 16384
    s_nop 0
    buffer_load_dwordx4 v2, s[8:11], s57 offen sc1 lds
p3w_85:
    s_waitcnt vmcnt(18)
    s_barrier
    s_waitcnt vmcnt(16)
    s_barrier
    s_waitcnt vmcnt(12)
    s_barrier
    s_waitcnt vmcnt(8)
    s_barrier
    s_waitcnt vmcnt(4)
    s_barrier
    s_waitcnt vmcnt(0)
    s_barrier
    s_waitcnt vmcnt(0)
    s_barrier
    s_barrier
concat_heads__linear_kernel_hedgehog__mha_block__prompt_kernel_p3done:
    s_endpgm
concat_heads__linear_kernel_hedgehog__mha_block__prompt_kernel_done:
    s_endpgm
concat_heads__linear_kernel_hedgehog__mha_block__prompt_kernel_end:
.section .rodata,"a"
.p2align 6
.amdhsa_kernel concat_heads__linear_kernel_hedgehog__mha_block__prompt_kernel
  .amdhsa_next_free_vgpr 256
  .amdhsa_next_free_sgpr 102
  .amdhsa_accum_offset 256
  .amdhsa_group_segment_fixed_size 0
  .amdhsa_kernarg_size 80
  .amdhsa_user_sgpr_count 2
  .amdhsa_user_sgpr_kernarg_segment_ptr 1
  .amdhsa_system_sgpr_workgroup_id_x 1
  .amdhsa_float_denorm_mode_32 3
.end_amdhsa_kernel
```
